```python
import torch

def _softmax(x, axis=-1):
    return torch.softmax(x, dim=axis)
def _gelu(x):
    return torch.nn.functional.gelu(x, approximate="tanh")
def _silu(x):
    return torch.nn.functional.silu(x)
def _sigmoid(x):
    return torch.sigmoid(x)
def _layernorm(x, axis=-1, eps=1e-5):
    m = x.mean(dim=axis, keepdim=True)
    v = x.var(dim=axis, keepdim=True, unbiased=False)
    return (x - m) / torch.sqrt(v + eps)
def _scatter_add(tgt, idx, src, axis=0):
    return tgt.clone().index_add_(axis, idx, src)
def _segment_sum(src, seg, n):
    out = torch.zeros((n,) + src.shape[1:], dtype=src.dtype)
    return out.index_add_(0, seg, src)
def _pad(x, pw):
    flat = tuple(v for pair in reversed(pw) for v in pair)
    return torch.nn.functional.pad(x, flat)

kernel_name = 'standalone__edge_featured_mpnn_mpnn__graph'

def setup_inputs():

    _w = (lambda a: (lambda t: t.to(torch.bfloat16) if t.is_floating_point() else t)(torch.as_tensor(a)))
    N, deg, D, De = 10000, 32, 128, max(16, 1)
    E = N * deg
    H = 2 * D
    return {
        "x": _w((lambda *s: torch.randn(*s, dtype=torch.bfloat16) * 0.05)(N, D)),
        "e_attr": _w((lambda *s: torch.randn(*s, dtype=torch.bfloat16) * 0.8)(E, De)),
        "src": _w((lambda lo, hi, *s: torch.randint(lo, hi, s))(0, N, E).to(torch.int64)),
        "dst": _w((lambda lo, hi, *s: torch.randint(lo, hi, s))(0, N, E).to(torch.int64)),
        "w1": _w((lambda *s: torch.randn(*s, dtype=torch.bfloat16) * 0.8)(2 * D + De, H) * (1.0 / (2 * D + De) ** 0.5)),
        "b1": _w((lambda *s: torch.randn(*s, dtype=torch.bfloat16) * 0.4)(H) * 0.01),
        "w2": _w((lambda *s: torch.randn(*s, dtype=torch.bfloat16) * 0.05)(H, D) * (1.0 / H ** 0.5)),
        "b2": _w((lambda *s: torch.randn(*s, dtype=torch.bfloat16) * 0.05)(D) * 0.01),
    }

def reference(x, e_attr, src, dst, w1, b1, w2, b2):
    N, D = x.shape
    h_src = x[src]
    h_dst = x[dst]
    m_in = torch.concatenate([h_src, h_dst, e_attr], axis=-1)
    h = _silu(m_in @ w1 + b1)
    msg = h @ w2 + b2
    return _segment_sum(msg, dst, N)
```

```asm
; @launch kernel=mpnn_pre_kernel grid=(238,1,1) block=(1024,1,1) lds=82176
; @launch kernel=mpnn_main_kernel grid=(256,1,1) block=(768,1,1) lds=163840
.amdgcn_target "amdgcn-amd-amdhsa--gfx950"
.text
.globl mpnn_pre_kernel
.p2align 8
.type mpnn_pre_kernel,@function
mpnn_pre_kernel:
    s_cmp_ge_u32 s2, 238
    s_cbranch_scc1 K1_END
    s_load_dwordx16 s[4:19], s[0:1], 0
    s_load_dwordx2 s[20:21], s[0:1], 80
    v_lshrrev_b32 v1, 6, v0
    v_and_b32 v2, 63, v0
    v_readfirstlane_b32 s22, v1
    s_cmp_ge_u32 s2, 157
    s_cbranch_scc1 K1_SORT
    v_lshrrev_b32 v10, 4, v0
    v_xor_b32 v11, v10, v2
    v_and_b32 v11, 15, v11
    v_lshlrev_b32 v11, 4, v11
    v_lshl_add_u32 v8, v10, 8, v11
    v_lshrrev_b32 v4, 4, v2
    v_lshlrev_b32 v7, 2, v4
    v_xor_b32 v7, v7, v2
    v_and_b32 v7, 15, v7
    v_lshlrev_b32 v7, 4, v7
    v_lshl_add_u32 v3, v4, 9, v7
    v_mov_b32 v14, 81920
    v_mov_b32 v15, 0
    ds_write_b32 v14, v15
    s_and_b32 s44, s22, 7
    s_lshl_b32 s45, s44, 13
    s_lshr_b32 s46, s22, 3
    s_lshl_b32 s47, s46, 8
    s_add_u32 s45, s45, s47
    s_lshl_b32 s47, s22, 12
    s_mul_i32 s48, s2, 16384
    s_lshl_b32 s49, s22, 10
    s_add_u32 m0, s49, 65536
    s_waitcnt lgkmcnt(0)
    s_mov_b32 s32, s4
    s_mov_b32 s33, s5
    s_mov_b32 s34, 2560000
    s_mov_b32 s35, 0x00020000
    s_mov_b32 s28, s12
    s_mov_b32 s29, s13
    s_mov_b32 s30, 139264
    s_mov_b32 s31, 0x00020000
    s_cmp_lg_u32 s22, 0
    s_cbranch_scc1 K1_NWU
    s_bfe_u32 s50, s2, 0x40003
    s_lshl_b32 s50, s50, 12
    v_and_b32 v12, 31, v2
    v_lshlrev_b32 v12, 7, v12
    buffer_load_dword v31, v12, s[28:31], s50 offen
K1_NWU:
    buffer_load_dwordx4 v8, s[32:35], s48 offen nt lds
    s_mov_b32 m0, s47
    s_cmp_lt_u32 s22, 8
    s_barrier
    s_cbranch_scc1 K1_GA
K1_GA:
    buffer_load_dwordx4 v3, s[28:31], s45 offen offset:0 lds
    s_add_u32 s45, s45, 1024
    buffer_load_dwordx4 v3, s[28:31], s45 offen offset:1024 lds
    s_add_u32 s45, s45, 1024
    buffer_load_dwordx4 v3, s[28:31], s45 offen offset:2048 lds
    s_add_u32 s45, s45, 1024
    buffer_load_dwordx4 v3, s[28:31], s45 offen offset:3072 lds
    s_add_u32 s45, s45, 1024
    s_cmp_lt_u32 s22, 8
    s_cbranch_scc1 K1_GC
    s_waitcnt vmcnt(4)
    s_barrier
    v_mov_b32 v15, 1
    s_waitcnt vmcnt(0)
    s_mov_b64 exec, 1
    ds_add_u32 v14, v15
    s_endpgm
K1_GC:
    v_lshrrev_b32 v5, 5, v2
    v_and_b32 v6, 31, v2
    s_bfe_u32 s26, s22, 0x10001
    s_lshr_b32 s27, s22, 2
    s_and_b32 s50, s22, 1
    s_lshl_b32 s50, s50, 7
    s_add_u32 s36, s20, 4096
    s_addc_u32 s37, s21, 0
    s_mov_b32 s38, 5120512
    s_mov_b32 s39, 0x00020000
    v_and_b32 v17, 15, v2
    v_xor_b32 v17, v17, v5
    s_lshl_b32 s51, s26, 13
    s_add_u32 s51, s51, 65536
    v_lshl_add_u32 v17, v17, 4, s51
    v_lshl_add_u32 v16, v6, 8, v17
    v_xor_b32 v17, 32, v16
    v_xor_b32 v18, 64, v16
    v_xor_b32 v19, 96, v16
    v_xor_b32 v20, 128, v16
    v_xor_b32 v21, 160, v16
    v_xor_b32 v22, 192, v16
    v_xor_b32 v23, 224, v16
    v_bfe_u32 v26, v2, 2, 2
    v_lshl_add_u32 v27, v5, 3, v26
    v_and_b32 v28, 3, v2
    v_lshl_add_u32 v28, v28, 3, s50
    v_bfe_u32 v29, v2, 4, 1
    v_lshl_add_u32 v28, v29, 5, v28
    v_lshlrev_b32 v26, 6, v26
    v_xor_b32 v28, v28, v26
    s_lshl_b32 s51, s27, 15
    v_add_u32 v28, s51, v28
    v_lshl_add_u32 v24, v27, 8, v28
    v_xor_b32 v25, 64, v24
    s_lshl_b32 s51, s27, 8
    s_add_u32 s51, s51, s50
    v_lshl_add_u32 v13, v6, 2, s51
    v_lshl_add_u32 v13, v5, 11, v13
    s_mul_i32 s52, s2, 32768
    s_lshl_b32 s51, s26, 14
    s_add_u32 s52, s52, s51
    s_add_u32 s53, s52, 4096
    s_add_u32 s54, s52, 8192
    s_add_u32 s55, s52, 12288
    s_mov_b32 s56, 0xbfb8aa3b
    s_mov_b32 s57, 0xbfb8aa3b
    s_waitcnt vmcnt(0)
    s_barrier
    s_cmp_eq_u32 s27, 0
    s_cbranch_scc1 K1_GO
K1_GW:
    ds_read_b32 v15, v14
    s_waitcnt lgkmcnt(0)
    v_readfirstlane_b32 s51, v15
    s_nop 0
    s_cmp_lt_u32 s51, 8
    s_cbranch_scc1 K1_GW
K1_GO:
    ds_read_b128 v[32:35], v16
    ds_read_b64_tr_b16 v[48:49], v24 offset:0
    ds_read_b64_tr_b16 v[50:51], v24 offset:1024
    ds_read_b64_tr_b16 v[52:53], v25 offset:0
    ds_read_b64_tr_b16 v[54:55], v25 offset:1024
    ds_read_b128 v[36:39], v17
    ds_read_b64_tr_b16 v[56:57], v24 offset:4096
    ds_read_b64_tr_b16 v[58:59], v24 offset:5120
    ds_read_b64_tr_b16 v[60:61], v25 offset:4096
    ds_read_b64_tr_b16 v[62:63], v25 offset:5120
    ds_read_b128 v[40:43], v18
    ds_read_b64_tr_b16 v[64:65], v24 offset:8192
    ds_read_b64_tr_b16 v[66:67], v24 offset:9216
    ds_read_b64_tr_b16 v[68:69], v25 offset:8192
    ds_read_b64_tr_b16 v[70:71], v25 offset:9216
    s_waitcnt lgkmcnt(10)
    v_mfma_f32_32x32x16_bf16 v[80:95], v[32:35], v[48:51], 0
    v_mfma_f32_32x32x16_bf16 v[96:111], v[32:35], v[52:55], 0
    ds_read_b128 v[44:47], v19
    ds_read_b64_tr_b16 v[72:73], v24 offset:12288
    ds_read_b64_tr_b16 v[74:75], v24 offset:13312
    ds_read_b64_tr_b16 v[76:77], v25 offset:12288
    ds_read_b64_tr_b16 v[78:79], v25 offset:13312
    s_waitcnt lgkmcnt(10)
    v_mfma_f32_32x32x16_bf16 v[80:95], v[36:39], v[56:59], v[80:95]
    v_mfma_f32_32x32x16_bf16 v[96:111], v[36:39], v[60:63], v[96:111]
    ds_read_b128 v[32:35], v20
    ds_read_b64_tr_b16 v[48:49], v24 offset:16384
    ds_read_b64_tr_b16 v[50:51], v24 offset:17408
    ds_read_b64_tr_b16 v[52:53], v25 offset:16384
    ds_read_b64_tr_b16 v[54:55], v25 offset:17408
    s_waitcnt lgkmcnt(10)
    v_mfma_f32_32x32x16_bf16 v[80:95], v[40:43], v[64:67], v[80:95]
    v_mfma_f32_32x32x16_bf16 v[96:111], v[40:43], v[68:71], v[96:111]
    ds_read_b128 v[36:39], v21
    ds_read_b64_tr_b16 v[56:57], v24 offset:20480
    ds_read_b64_tr_b16 v[58:59], v24 offset:21504
    ds_read_b64_tr_b16 v[60:61], v25 offset:20480
    ds_read_b64_tr_b16 v[62:63], v25 offset:21504
    s_waitcnt lgkmcnt(10)
    v_mfma_f32_32x32x16_bf16 v[80:95], v[44:47], v[72:75], v[80:95]
    v_mfma_f32_32x32x16_bf16 v[96:111], v[44:47], v[76:79], v[96:111]
    ds_read_b128 v[40:43], v22
    ds_read_b64_tr_b16 v[64:65], v24 offset:24576
    ds_read_b64_tr_b16 v[66:67], v24 offset:25600
    ds_read_b64_tr_b16 v[68:69], v25 offset:24576
    ds_read_b64_tr_b16 v[70:71], v25 offset:25600
    s_waitcnt lgkmcnt(10)
    v_mfma_f32_32x32x16_bf16 v[80:95], v[32:35], v[48:51], v[80:95]
    v_mfma_f32_32x32x16_bf16 v[96:111], v[32:35], v[52:55], v[96:111]
    ds_read_b128 v[44:47], v23
    ds_read_b64_tr_b16 v[72:73], v24 offset:28672
    ds_read_b64_tr_b16 v[74:75], v24 offset:29696
    ds_read_b64_tr_b16 v[76:77], v25 offset:28672
    ds_read_b64_tr_b16 v[78:79], v25 offset:29696
    s_waitcnt lgkmcnt(10)
    v_mfma_f32_32x32x16_bf16 v[80:95], v[36:39], v[56:59], v[80:95]
    v_mfma_f32_32x32x16_bf16 v[96:111], v[36:39], v[60:63], v[96:111]
    s_waitcnt lgkmcnt(5)
    v_mfma_f32_32x32x16_bf16 v[80:95], v[40:43], v[64:67], v[80:95]
    v_mfma_f32_32x32x16_bf16 v[96:111], v[40:43], v[68:71], v[96:111]
    s_waitcnt lgkmcnt(0)
    v_mfma_f32_32x32x16_bf16 v[80:95], v[44:47], v[72:75], v[80:95]
    v_mfma_f32_32x32x16_bf16 v[96:111], v[44:47], v[76:79], v[96:111]
    s_nop 10
    v_pk_mul_f32 v[80:81], v[80:81], s[56:57]
    v_pk_mul_f32 v[96:97], v[96:97], s[56:57]
    v_cvt_pk_bf16_f32 v32, v80, v96
    buffer_store_dword v32, v13, s[36:39], s52 offen offset:0 sc1
    v_cvt_pk_bf16_f32 v33, v81, v97
    buffer_store_dword v33, v13, s[36:39], s52 offen offset:512 sc1
    v_pk_mul_f32 v[82:83], v[82:83], s[56:57]
    v_pk_mul_f32 v[98:99], v[98:99], s[56:57]
    v_cvt_pk_bf16_f32 v34, v82, v98
    buffer_store_dword v34, v13, s[36:39], s52 offen offset:1024 sc1
    v_cvt_pk_bf16_f32 v35, v83, v99
    buffer_store_dword v35, v13, s[36:39], s52 offen offset:1536 sc1
    v_pk_mul_f32 v[84:85], v[84:85], s[56:57]
    v_pk_mul_f32 v[100:101], v[100:101], s[56:57]
    v_cvt_pk_bf16_f32 v36, v84, v100
    buffer_store_dword v36, v13, s[36:39], s53 offen offset:0 sc1
    v_cvt_pk_bf16_f32 v37, v85, v101
    buffer_store_dword v37, v13, s[36:39], s53 offen offset:512 sc1
    v_pk_mul_f32 v[86:87], v[86:87], s[56:57]
    v_pk_mul_f32 v[102:103], v[102:103], s[56:57]
    v_cvt_pk_bf16_f32 v38, v86, v102
    buffer_store_dword v38, v13, s[36:39], s53 offen offset:1024 sc1
    v_cvt_pk_bf16_f32 v39, v87, v103
    buffer_store_dword v39, v13, s[36:39], s53 offen offset:1536 sc1
    v_pk_mul_f32 v[88:89], v[88:89], s[56:57]
    v_pk_mul_f32 v[104:105], v[104:105], s[56:57]
    v_cvt_pk_bf16_f32 v40, v88, v104
    buffer_store_dword v40, v13, s[36:39], s54 offen offset:0 sc1
    v_cvt_pk_bf16_f32 v41, v89, v105
    buffer_store_dword v41, v13, s[36:39], s54 offen offset:512 sc1
    v_pk_mul_f32 v[90:91], v[90:91], s[56:57]
    v_pk_mul_f32 v[106:107], v[106:107], s[56:57]
    v_cvt_pk_bf16_f32 v42, v90, v106
    buffer_store_dword v42, v13, s[36:39], s54 offen offset:1024 sc1
    v_cvt_pk_bf16_f32 v43, v91, v107
    buffer_store_dword v43, v13, s[36:39], s54 offen offset:1536 sc1
    v_pk_mul_f32 v[92:93], v[92:93], s[56:57]
    v_pk_mul_f32 v[108:109], v[108:109], s[56:57]
    v_cvt_pk_bf16_f32 v44, v92, v108
    buffer_store_dword v44, v13, s[36:39], s55 offen offset:0 sc1
    v_cvt_pk_bf16_f32 v45, v93, v109
    buffer_store_dword v45, v13, s[36:39], s55 offen offset:512 sc1
    v_pk_mul_f32 v[94:95], v[94:95], s[56:57]
    v_pk_mul_f32 v[110:111], v[110:111], s[56:57]
    v_cvt_pk_bf16_f32 v46, v94, v110
    buffer_store_dword v46, v13, s[36:39], s55 offen offset:1024 sc1
    v_cvt_pk_bf16_f32 v47, v95, v111
    buffer_store_dword v47, v13, s[36:39], s55 offen offset:1536 sc1
    s_endpgm
K1_SORT:
    s_sub_u32 s3, s2, 157
    s_cmp_ge_u32 s3, 64
    s_cbranch_scc1 K1_HELP
    s_and_b32 s24, s3, 7
    s_lshl_b32 s24, s24, 4
    s_lshr_b32 s25, s3, 3
    s_lshl_b32 s25, s25, 1
    s_add_u32 s24, s24, s25
    s_lshr_b32 s25, s22, 3
    s_add_u32 s3, s24, s25
    s_mul_i32 s54, s25, 36864
    v_mov_b32 v47, v0
    v_and_b32 v0, 511, v0
    v_lshlrev_b32 v3, 2, v0
    v_add_u32 v4, 4096, v3
    v_add_u32 v5, 8192, v3
    s_mul_i32 s23, s3, 10000
    s_waitcnt lgkmcnt(0)
    s_mov_b32 s32, s10
    s_mov_b32 s33, s11
    s_mov_b32 s34, 1280000
    s_mov_b32 s35, 0x00020000
    buffer_load_dword v10, v3, s[32:35], s23 offen offset:0 nt
    buffer_load_dword v11, v3, s[32:35], s23 offen offset:2048 nt
    buffer_load_dword v12, v4, s[32:35], s23 offen offset:0 nt
    buffer_load_dword v13, v4, s[32:35], s23 offen offset:2048 nt
    buffer_load_dword v14, v5, s[32:35], s23 offen offset:0 nt
    s_mov_b32 s28, s8
    s_mov_b32 s29, s9
    s_mov_b32 s30, 1280000
    s_mov_b32 s31, 0x00020000
    s_barrier
    buffer_load_dword v16, v3, s[28:31], s23 offen offset:0 nt
    buffer_load_dword v17, v3, s[28:31], s23 offen offset:2048 nt
    buffer_load_dword v18, v4, s[28:31], s23 offen offset:0 nt
    buffer_load_dword v19, v4, s[28:31], s23 offen offset:2048 nt
    buffer_load_dword v20, v5, s[28:31], s23 offen offset:0 nt
    v_mov_b32 v24, -1
    v_mov_b32 v25, -1
    v_mov_b32 v26, -1
    v_mov_b32 v27, -1
    v_mov_b32 v28, 0
    v_lshl_add_u32 v6, v0, 4, s54
    v_add_u32 v7, s54, v3
    ds_write_b32 v7, v28 offset:32768
    ds_write_b128 v6, v[24:27] offset:0
    ds_write_b128 v6, v[24:27] offset:8192
    ds_write_b128 v6, v[24:27] offset:16384
    ds_write_b128 v6, v[24:27] offset:24576
    s_add_u32 s36, s20, 10485760
    s_addc_u32 s37, s21, 0
    s_mov_b32 s38, 4194304
    s_mov_b32 s39, 0x00020000
    v_mov_b32 v29, 1
    v_mov_b32 v30, -2
    v_lshlrev_b32 v31, 6, v0
    v_lshrrev_b32 v44, 3, v47
    v_and_b32 v45, 3, v47
    v_lshlrev_b32 v45, 1, v45
    v_xor_b32 v45, v45, v44
    v_and_b32 v45, 7, v45
    v_lshlrev_b32 v45, 4, v45
    v_lshl_add_u32 v45, v44, 7, v45
    v_bfe_u32 v43, v47, 2, 1
    v_mul_u32_u24 v43, 36864, v43
    v_add_u32 v45, v45, v43
    v_xor_b32 v42, 16, v45
    v_lshl_add_u32 v43, v44, 2, v43
    v_and_b32 v46, 7, v47
    v_lshlrev_b32 v46, 4, v46
    v_lshl_add_u32 v46, v44, 13, v46
    s_lshr_b32 s24, s3, 1
    s_lshl_b32 s24, s24, 7
    s_add_u32 s25, s24, 1048576
    s_add_u32 s26, s24, 2097152
    s_add_u32 s27, s24, 3145728
    v_add_u32 v84, 0, v31
    v_add_u32 v85, 32768, v31
    v_add_u32 v86, 65536, v31
    v_add_u32 v87, 98304, v31
    v_add_u32 v88, 131072, v31
    v_cmp_gt_u32 vcc, 452, v0
    s_waitcnt lgkmcnt(0)
    s_mov_b64 s[52:53], vcc
    s_barrier
    s_waitcnt vmcnt(9)
    v_and_b32 v32, 255, v10
    v_lshl_add_u32 v37, v32, 2, s54
    ds_add_rtn_u32 v60, v37, v29 offset:32768
    s_waitcnt vmcnt(8)
    v_and_b32 v33, 255, v11
    v_lshl_add_u32 v38, v33, 2, s54
    ds_add_rtn_u32 v61, v38, v29 offset:32768
    s_waitcnt vmcnt(7)
    v_and_b32 v34, 255, v12
    v_lshl_add_u32 v39, v34, 2, s54
    ds_add_rtn_u32 v62, v39, v29 offset:32768
    s_waitcnt vmcnt(6)
    v_and_b32 v35, 255, v13
    v_lshl_add_u32 v40, v35, 2, s54
    ds_add_rtn_u32 v63, v40, v29 offset:32768
    s_waitcnt vmcnt(5)
    v_and_b32 v36, 255, v14
    v_lshl_add_u32 v41, v36, 2, s54
    s_mov_b64 exec, s[52:53]
    ds_add_rtn_u32 v64, v41, v29 offset:32768
    s_mov_b64 exec, -1
    s_waitcnt vmcnt(4)
    v_lshrrev_b32 v10, 8, v10
    v_lshl_or_b32 v10, v16, 18, v10
    v_or_b32 v10, v10, v84
    v_and_b32 v16, 28, v37
    v_lshlrev_b32 v32, 5, v32
    s_waitcnt vmcnt(3)
    v_lshrrev_b32 v11, 8, v11
    v_lshl_or_b32 v11, v17, 18, v11
    v_or_b32 v11, v11, v85
    v_and_b32 v17, 28, v38
    v_lshlrev_b32 v33, 5, v33
    s_waitcnt vmcnt(2)
    v_lshrrev_b32 v12, 8, v12
    v_lshl_or_b32 v12, v18, 18, v12
    v_or_b32 v12, v12, v86
    v_and_b32 v18, 28, v39
    v_lshlrev_b32 v34, 5, v34
    s_waitcnt vmcnt(1)
    v_lshrrev_b32 v13, 8, v13
    v_lshl_or_b32 v13, v19, 18, v13
    v_or_b32 v13, v13, v87
    v_and_b32 v19, 28, v40
    v_lshlrev_b32 v35, 5, v35
    s_waitcnt vmcnt(0)
    v_lshrrev_b32 v14, 8, v14
    v_lshl_or_b32 v14, v20, 18, v14
    v_or_b32 v14, v14, v88
    v_and_b32 v20, 28, v41
    v_lshlrev_b32 v36, 5, v36
    s_waitcnt lgkmcnt(4)
    v_cmp_lt_u32 vcc, 30, v60
    v_min_u32 v60, 31, v60
    v_lshl_or_b32 v60, v60, 5, v60
    v_bfe_u32 v60, v60, 2, 5
    v_xad_u32 v60, v60, v16, v32
    v_cndmask_b32 v10, v10, v30, vcc
    v_lshl_add_u32 v60, v60, 2, s54
    ds_write_b32 v60, v10
    s_waitcnt lgkmcnt(4)
    v_cmp_lt_u32 vcc, 30, v61
    v_min_u32 v61, 31, v61
    v_lshl_or_b32 v61, v61, 5, v61
    v_bfe_u32 v61, v61, 2, 5
    v_xad_u32 v61, v61, v17, v33
    v_cndmask_b32 v11, v11, v30, vcc
    v_lshl_add_u32 v61, v61, 2, s54
    ds_write_b32 v61, v11
    s_waitcnt lgkmcnt(4)
    v_cmp_lt_u32 vcc, 30, v62
    v_min_u32 v62, 31, v62
    v_lshl_or_b32 v62, v62, 5, v62
    v_bfe_u32 v62, v62, 2, 5
    v_xad_u32 v62, v62, v18, v34
    v_cndmask_b32 v12, v12, v30, vcc
    v_lshl_add_u32 v62, v62, 2, s54
    ds_write_b32 v62, v12
    s_waitcnt lgkmcnt(4)
    v_cmp_lt_u32 vcc, 30, v63
    v_min_u32 v63, 31, v63
    v_lshl_or_b32 v63, v63, 5, v63
    v_bfe_u32 v63, v63, 2, 5
    v_xad_u32 v63, v63, v19, v35
    v_cndmask_b32 v13, v13, v30, vcc
    v_lshl_add_u32 v63, v63, 2, s54
    ds_write_b32 v63, v13
    s_waitcnt lgkmcnt(4)
    v_cmp_lt_u32 vcc, 30, v64
    v_min_u32 v64, 31, v64
    v_lshl_or_b32 v64, v64, 5, v64
    v_bfe_u32 v64, v64, 2, 5
    v_xad_u32 v64, v64, v20, v36
    v_cndmask_b32 v14, v14, v30, vcc
    v_lshl_add_u32 v64, v64, 2, s54
    s_mov_b64 exec, s[52:53]
    ds_write_b32 v64, v14
    s_mov_b64 exec, -1
    s_waitcnt lgkmcnt(0)
    s_barrier
    ds_read_b128 v[64:67], v45 offset:0
    ds_read_b128 v[68:71], v45 offset:16384
    ds_read_b32 v80, v43 offset:32768
    ds_read_b128 v[72:75], v42 offset:0
    ds_read_b32 v81, v43 offset:33280
    ds_read_b128 v[76:79], v42 offset:16384
    s_waitcnt lgkmcnt(5)
    buffer_store_dwordx4 v[64:67], v46, s[36:39], s24 offen sc1
    s_waitcnt lgkmcnt(4)
    buffer_store_dwordx4 v[68:71], v46, s[36:39], s25 offen sc1
    s_waitcnt lgkmcnt(2)
    v_cmp_lt_u32 vcc, 15, v80
    s_and_saveexec_b64 s[52:53], vcc
    s_cbranch_execz K1_NB0
    buffer_store_dwordx4 v[72:75], v46, s[36:39], s26 offen sc1
K1_NB0:
    s_mov_b64 exec, -1
    s_waitcnt lgkmcnt(0)
    v_cmp_lt_u32 vcc, 15, v81
    s_and_saveexec_b64 s[52:53], vcc
    s_cbranch_execz K1_NB1
    buffer_store_dwordx4 v[76:79], v46, s[36:39], s27 offen sc1
K1_NB1:
    s_mov_b64 exec, -1
    s_endpgm
K1_HELP:
    s_sub_u32 s3, s3, 64
    s_waitcnt lgkmcnt(0)
    s_add_u32 s40, s20, 14680064
    s_addc_u32 s41, s21, 0
    s_mov_b32 s42, 139264
    s_mov_b32 s43, 0x00020000
    v_lshlrev_b32 v6, 4, v2
    s_cmp_lt_u32 s22, 8
    s_cbranch_scc1 K1_H8
    s_cmp_lt_u32 s22, 10
    s_cbranch_scc0 K1_END
    s_getpc_b64 s[60:61]
K1_PC:
    s_add_u32 s60, s60, mpnn_main_kernel-K1_PC
    s_addc_u32 s61, s61, 0
    s_mov_b32 s62, K2_REDO-mpnn_main_kernel
    s_mov_b32 s63, 0x00020000
    v_subrev_u32 v7, 512, v0
    v_lshlrev_b32 v7, 7, v7
    buffer_load_dword v22, v7, s[60:63], 0 offen
    s_endpgm
K1_H8:
    s_lshl_b32 s3, s3, 3
    s_add_u32 s3, s3, s22
    s_mov_b32 s58, s3
    s_bfe_u32 s26, s3, 0x30003
    s_and_b32 s27, s3, 7
    s_cmp_ge_u32 s3, 128
    s_cselect_b32 s26, s27, s26
    s_cselect_b32 s27, 8, s27
    s_cmp_ge_u32 s3, 64
    s_cbranch_scc1 K1_PREP1
    s_mov_b32 s44, s16
    s_mov_b32 s45, s17
    s_mov_b32 s46, 65536
    s_mov_b32 s47, 0x00020000
    v_and_b32 v40, 15, v2
    v_lshlrev_b32 v40, 1, v40
    v_lshrrev_b32 v41, 4, v2
    v_lshl_add_u32 v40, v41, 10, v40
    v_add_u32 v41, 8192, v40
    s_bfe_u32 s24, s3, 0x20001
    s_lshl_b32 s24, s24, 14
    s_and_b32 s25, s3, 1
    s_lshl_b32 s25, s25, 12
    s_add_u32 s24, s24, s25
    s_lshr_b32 s25, s3, 3
    s_lshl_b32 s25, s25, 5
    s_add_u32 s24, s24, s25
    buffer_load_ushort v48, v40, s[44:47], s24 offen offset:0
    buffer_load_ushort v49, v41, s[44:47], s24 offen offset:0
    buffer_load_ushort v50, v40, s[44:47], s24 offen offset:256
    buffer_load_ushort v51, v41, s[44:47], s24 offen offset:256
    buffer_load_ushort v52, v40, s[44:47], s24 offen offset:512
    buffer_load_ushort v53, v41, s[44:47], s24 offen offset:512
    buffer_load_ushort v54, v40, s[44:47], s24 offen offset:768
    buffer_load_ushort v55, v41, s[44:47], s24 offen offset:768
    s_branch K1_PFIN
K1_PREP1:
    s_mov_b32 s44, s12
    s_mov_b32 s45, s13
    s_mov_b32 s46, 139264
    s_mov_b32 s47, 0x00020000
    v_and_b32 v42, 1, v2
    v_lshlrev_b32 v42, 6, v42
    v_and_b32 v43, 30, v2
    v_add_u32 v42, v42, v43
    v_lshrrev_b32 v43, 5, v2
    v_lshl_add_u32 v42, v43, 12, v42
    s_lshr_b32 s24, s26, 1
    s_lshl_b32 s24, s24, 7
    s_and_b32 s25, s26, 1
    s_lshl_b32 s25, s25, 5
    s_add_u32 s24, s24, s25
    s_lshl_b32 s27, s27, 13
    s_add_u32 s24, s24, s27
    s_add_u32 s24, s24, 65536
    buffer_load_ushort v48, v42, s[44:47], s24 offen offset:0
    buffer_load_ushort v49, v42, s[44:47], s24 offen offset:512
    buffer_load_ushort v50, v42, s[44:47], s24 offen offset:1024
    buffer_load_ushort v51, v42, s[44:47], s24 offen offset:1536
    buffer_load_ushort v52, v42, s[44:47], s24 offen offset:2048
    buffer_load_ushort v53, v42, s[44:47], s24 offen offset:2560
    buffer_load_ushort v54, v42, s[44:47], s24 offen offset:3072
    buffer_load_ushort v55, v42, s[44:47], s24 offen offset:3584
K1_PFIN:
    s_lshl_b32 s24, s58, 10
    s_cmp_ge_u32 s58, 128
    s_waitcnt vmcnt(0)
    s_cbranch_scc1 K1_FINC
    v_lshl_or_b32 v56, v49, 16, v48
    v_lshl_or_b32 v57, v51, 16, v50
    v_lshl_or_b32 v58, v53, 16, v52
    v_lshl_or_b32 v59, v55, 16, v54
    buffer_store_dwordx4 v[56:59], v6, s[40:43], s24 offen sc1
    s_endpgm
K1_FINC:
    s_mov_b32 s25, 0xbfb8aa3b
    v_lshlrev_b32 v48, 16, v48
    v_mul_f32 v48, s25, v48
    v_lshlrev_b32 v49, 16, v49
    v_mul_f32 v49, s25, v49
    v_lshlrev_b32 v50, 16, v50
    v_mul_f32 v50, s25, v50
    v_lshlrev_b32 v51, 16, v51
    v_mul_f32 v51, s25, v51
    v_lshlrev_b32 v52, 16, v52
    v_mul_f32 v52, s25, v52
    v_lshlrev_b32 v53, 16, v53
    v_mul_f32 v53, s25, v53
    v_lshlrev_b32 v54, 16, v54
    v_mul_f32 v54, s25, v54
    v_lshlrev_b32 v55, 16, v55
    v_mul_f32 v55, s25, v55
    v_cvt_pk_bf16_f32 v56, v48, v49
    v_cvt_pk_bf16_f32 v57, v50, v51
    v_cvt_pk_bf16_f32 v58, v52, v53
    v_cvt_pk_bf16_f32 v59, v54, v55
    buffer_store_dwordx4 v[56:59], v6, s[40:43], s24 offen sc1
K1_END:
    s_endpgm
.globl mpnn_main_kernel
.p2align 8
.type mpnn_main_kernel,@function
mpnn_main_kernel:
    s_cmp_ge_u32 s2, 256
    s_cbranch_scc1 K2_END
    s_mov_b32 s70, 0
K2_TOP:
    s_load_dwordx2 s[22:23], s[0:1], 80
    s_load_dwordx16 s[4:19], s[0:1], 0
    s_load_dwordx2 s[20:21], s[0:1], 64
    v_lshrrev_b32 v72, 6, v0
    v_and_b32 v1, 63, v0
    v_readfirstlane_b32 s24, v72
    v_lshlrev_b32 v24, 4, v0
    v_lshlrev_b32 v6, 4, v1
    s_lshl_b32 s66, s2, 13
    s_add_u32 s67, s66, 2097152
    s_and_b32 s25, s24, 3
    s_lshr_b32 s26, s24, 2
    s_cmp_ge_u32 s24, 8
    s_cbranch_scc1 K2_HL
    s_waitcnt lgkmcnt(0)
    s_add_u32 s40, s22, 10485760
    s_addc_u32 s41, s23, 0
    s_mov_b32 s42, 4333568
    s_mov_b32 s43, 0x00020000
    buffer_load_dwordx4 v[16:19], v24, s[40:43], s66 offen
    buffer_load_dwordx4 v[20:23], v24, s[40:43], s67 offen nt
    s_branch K2_CM
K2_HL:
    v_lshrrev_b32 v77, 4, v1
    s_lshl_b32 s68, s25, 2
    v_add_u32 v77, s68, v77
    v_xor_b32 v27, v77, v1
    v_and_b32 v27, 15, v27
    v_lshlrev_b32 v27, 4, v27
    v_lshl_add_u32 v26, v77, 16, v27
    v_subrev_u32 v78, 12, v77
    v_and_b32 v78, 15, v78
    v_add_u32 v78, 12, v78
    v_lshl_add_u32 v28, v78, 16, v27
    v_subrev_u32 v78, 24, v77
    v_and_b32 v78, 15, v78
    v_add_u32 v78, 24, v78
    v_lshl_add_u32 v29, v78, 16, v27
    s_lshl_b32 s68, s2, 8
    s_lshl_b32 s69, s25, 10
    s_add_u32 m0, s69, 53248
    s_waitcnt lgkmcnt(0)
    s_mov_b32 s36, s4
    s_mov_b32 s37, s5
    s_mov_b32 s38, 2560000
    s_mov_b32 s39, 0x00020000
    buffer_load_dwordx4 v26, s[36:39], s68 offen lds
    s_add_u32 m0, s69, 69632
    s_add_u32 s40, s22, 10485760
    s_addc_u32 s41, s23, 0
    s_mov_b32 s42, 4333568
    s_mov_b32 s43, 0x00020000
    buffer_load_dwordx4 v28, s[36:39], s68 offen lds
    s_add_u32 m0, s69, 86016
    s_lshr_b32 s66, s2, 3
    buffer_load_dwordx4 v29, s[36:39], s68 offen lds
    s_mul_i32 s66, s66, 4352
    s_mul_i32 s67, s25, 1152
    s_add_u32 s66, s66, s67
    s_add_u32 s66, s66, 4194304
    v_min_u32 v30, 8, v1
    v_lshlrev_b32 v30, 7, v30
    buffer_load_dword v134, v30, s[40:43], s66 offen
K2_CM:
    s_mul_i32 s71, s26, 12
    s_lshl_b32 s56, s26, 14
    s_add_u32 s56, s56, 49152
    s_lshl_b32 s69, s25, 10
    s_add_u32 s59, s56, s69
    s_lshl_b32 s66, s24, 13
    s_add_u32 s73, s66, 4194304
    s_cmp_lt_u32 s24, 8
    s_cselect_b32 s73, s73, 0x40000000
    s_add_u32 s74, s73, 4096
    s_lshl_b32 s72, s25, 11
    s_add_u32 s72, s72, 4325376
    v_add_u32 v156, 98304, v24
    v_mov_b32 v144, 0
    v_mov_b32 v145, 0
    v_mov_b32 v146, 0
    v_mov_b32 v147, 0
    v_mov_b32 v31, 10001
    v_mov_b32 v152, 320000
    v_cmp_gt_u32 vcc, 9728, v24
    v_mov_b32 v153, v152
    v_mov_b32 v154, v152
    v_cndmask_b32 v148, v152, v31, vcc
    v_mov_b32 v155, v152
    v_mov_b32 v149, v148
    v_mov_b32 v150, v148
    v_mov_b32 v151, v148
    v_cmpx_le_u32 vcc, 3328, v24
    ds_write_b128 v156, v[148:151] offset:49152
    s_mov_b64 exec, -1
    s_cmp_lg_u32 s24, 0
    s_cbranch_scc1 K2_I0
    ds_write_b128 v156, v[144:147] offset:49152
    ds_write_b128 v156, v[144:147] offset:50176
    ds_write_b128 v156, v[144:147] offset:51200
    s_mov_b64 exec, 0xffff
    ds_write_b128 v156, v[144:147] offset:52224
    s_mov_b64 exec, -1
K2_I0:
    ds_write_b128 v156, v[144:147] offset:0
    ds_write_b128 v156, v[144:147] offset:12288
    ds_write_b128 v156, v[144:147] offset:24576
    ds_write_b128 v156, v[144:147] offset:36864
    s_cmp_lt_u32 s24, 4
    s_cbranch_scc0 K2_I1
    ds_write_b128 v156, v[152:155] offset:61440
K2_I1:
    v_lshrrev_b32 v72, 2, v0
    v_mov_b32 v111, 148736
    v_mov_b32 v114, 1
    s_lshl_b32 s57, s24, 12
    s_lshl_b32 s58, s25, 7
K2_SET:
    s_mov_b32 s84, s6
    s_and_b32 s85, s7, 0xffff
    s_or_b32 s85, s85, 0x200000
    s_mov_b32 s87, 0x00020000
    s_add_u32 s32, s22, 1024
    s_addc_u32 s33, s23, 0
    s_and_b32 s33, s33, 0xffff
    s_or_b32 s33, s33, 0x2000000
    s_mov_b32 s34, 10001
    s_mov_b32 s35, 0x00020000
    s_mov_b32 s44, s20
    s_mov_b32 s45, s21
    s_mov_b32 s46, 2560000
    s_mov_b32 s47, 0x00020000
    v_lshrrev_b32 v77, 5, v1
    v_and_b32 v78, 31, v1
    v_bfe_u32 v105, v1, 3, 2
    v_bfe_u32 v106, v1, 1, 1
    v_lshl_or_b32 v105, v105, 1, v106
    v_and_b32 v106, 1, v1
    v_lshl_or_b32 v105, v106, 3, v105
    v_and_b32 v106, 4, v1
    v_lshl_or_b32 v105, v106, 2, v105
    s_mov_b32 m0, s57
    s_add_u32 s28, s58, 3072
    s_add_u32 s29, s58, 2048
    s_add_u32 s30, s58, 1024
    s_add_u32 s31, s58, 0
    v_and_b32 v106, 3, v1
    v_lshl_add_u32 v2, v106, 3, s57
    v_and_b32 v106, 16, v1
    v_lshl_add_u32 v2, v106, 1, v2
    v_lshl_add_u32 v2, v77, 11, v2
    v_and_b32 v106, 8, v1
    v_mul_u32_u24 v106, 136, v106
    v_add_u32 v2, v2, v106
    v_xor_b32 v3, 64, v2
    s_mov_b32 exec_lo, 0x0f0f0f0f
    s_mov_b32 exec_hi, 0x0f0f0f0f
    v_mov_b32 v2, 149632
    v_mov_b32 v3, 149632
    s_mov_b64 exec, -1
    v_bfe_u32 v106, v105, 3, 1
    v_xor_b32 v106, v106, v77
    v_lshl_add_u32 v106, v106, 4, s56
    v_lshl_add_u32 v110, v105, 5, v106
    s_add_u32 s52, s56, 49152
    v_lshl_add_u32 v106, v77, 4, s52
    v_lshl_add_u32 v7, v105, 5, v106
    s_lshl_b32 s66, s26, 11
    s_add_u32 s67, s66, 157184
    s_add_u32 s66, s66, 150784
    v_and_b32 v106, 62, v1
    v_lshl_add_u32 v11, v106, 1, s67
    v_lshrrev_b32 v106, 3, v1
    v_lshl_add_u32 v10, v106, 2, s66
    v_add_u32 v4, s58, v11
    v_and_b32 v106, 8, v1
    v_lshl_add_u32 v104, v106, 4, s52
    v_lshl_add_u32 v104, v77, 9, v104
    v_and_b32 v106, 4, v1
    v_lshl_add_u32 v104, v106, 6, v104
    v_and_b32 v106, 3, v1
    v_lshl_add_u32 v104, v106, 3, v104
    s_mov_b32 s62, 0xffff
    s_mov_b32 s63, 0xffff
    s_mov_b32 s64, 0xffff0000
    s_mov_b32 s65, 0xffff0000
    v_mov_b32 v105, 147696
    v_cndmask_b32 v8, v105, v104, s[62:63]
    v_cndmask_b32 v9, v105, v104, s[64:65]
    v_lshrrev_b32 v106, 4, v1
    v_xor_b32 v106, v106, v1
    v_mov_b32 v12, -1
    v_and_b32 v13, 1, v106
    v_lshlrev_b32 v13, 4, v13
    v_and_b32 v106, 7, v1
    v_lshlrev_b32 v137, 4, v106
    v_xor_b32 v139, 64, v137
    v_mov_b32 v141, v137
    v_mov_b32 v143, v139
    v_mov_b32 v75, 0x3f80
    s_lshl_b32 s66, s25, 11
    s_add_u32 s67, s56, s66
    v_add_u32 v115, s67, v6
    s_mov_b32 s55, 0
    s_mov_b32 s60, 0
    s_mov_b32 s61, s25
    s_cmp_ge_u32 s24, 8
    s_cbranch_scc1 K2_HQ
    s_mov_b32 s66, 2500
    v_mul_u32_u24 v72, s66, v72
    s_mov_b32 s78, 147456
    v_lshl_add_u32 v76, v1, 2, s78
    s_mov_b32 s79, 150784
    s_mov_b32 s80, 98304
    s_mov_b32 s81, 0
    s_mov_b32 s68, 0x6002000
    s_mov_b32 s69, 0x80
    v_mov_b32 v40, -1
    v_mov_b32 v41, -1
    v_mov_b32 v42, -1
    v_mov_b32 v43, -1
    v_mov_b32 v44, -1
    v_mov_b32 v45, -1
    v_mov_b32 v46, -1
    v_mov_b32 v47, -1
    v_mov_b32 v73, -24
    v_mov_b32 v74, 44
    v_cndmask_b32 v73, 0, v73, s[68:69]
    s_cmp_lg_u32 s24, 0
    s_cbranch_scc1 K2_NCI
    v_lshlrev_b32 v105, 18, v1
    s_mov_b64 exec, 0x1000
    v_add_u32 v105, 0x1d00000, v105
    s_mov_b64 exec, 0x1ffc000
    v_add_u32 v105, 0x1cc0000, v105
    s_mov_b32 exec_lo, 0xf8000000
    s_mov_b32 exec_hi, 0x7f
    v_add_u32 v105, 0x3940000, v105
    s_mov_b64 exec, s[68:69]
    v_mov_b32 v105, 24
    s_mov_b32 exec_lo, -1
    s_mov_b32 exec_hi, 0xff
    ds_write_b32 v76, v105 offset:0
    ds_write_b32 v76, v105 offset:256
    ds_write_b32 v76, v105 offset:512
    ds_write_b32 v76, v105 offset:768
    ds_write_b32 v76, v105 offset:1024
    s_mov_b64 exec, -1
K2_NCI:
    buffer_load_dwordx4 v[80:83], v6, s[40:43], s72 offen
    buffer_load_dwordx4 v[84:87], v6, s[40:43], s72 offen offset:1024
    s_waitcnt lgkmcnt(0)
    s_barrier
    s_waitcnt vmcnt(3)
    v_mov_b32_dpp v25, v19 quad_perm:[3,3,3,3] row_mask:0xf bank_mask:0xf
    v_and_b32 v32, 63, v16
    v_lshrrev_b32 v88, 29, v16
    v_lshl_add_u32 v32, v32, 2, s78
    v_lshl_add_u32 v32, v88, 8, v32
    v_and_b32 v33, 63, v17
    v_lshrrev_b32 v89, 29, v17
    v_lshl_add_u32 v33, v33, 2, s78
    v_lshl_add_u32 v33, v89, 8, v33
    v_and_b32 v34, 63, v18
    v_lshrrev_b32 v90, 29, v18
    v_lshl_add_u32 v34, v34, 2, s78
    v_lshl_add_u32 v34, v90, 8, v34
    v_and_b32 v35, 63, v19
    v_lshrrev_b32 v91, 29, v19
    v_lshl_add_u32 v35, v35, 2, s78
    v_lshl_add_u32 v35, v91, 8, v35
    v_cmpx_gt_u32 vcc, -2, v16
    ds_add_rtn_u32 v40, v32, v114
    v_cmpx_gt_u32 vcc, -2, v17
    ds_add_rtn_u32 v41, v33, v114
    v_cmpx_gt_u32 vcc, -2, v18
    ds_add_rtn_u32 v42, v34, v114
    v_cmpx_gt_u32 vcc, -2, v19
    ds_add_rtn_u32 v43, v35, v114
    s_mov_b64 exec, -1
    v_cmp_ne_u32 vcc, -1, v25
    s_nop 1
    s_cbranch_vccz K2_C1
    s_waitcnt vmcnt(2)
    v_cndmask_b32 v20, -1, v20, vcc
    v_cndmask_b32 v21, -1, v21, vcc
    v_cndmask_b32 v22, -1, v22, vcc
    v_cndmask_b32 v23, -1, v23, vcc
    s_mov_b32 s81, 1
    v_and_b32 v36, 63, v20
    v_lshrrev_b32 v92, 29, v20
    v_lshl_add_u32 v36, v36, 2, s78
    v_lshl_add_u32 v36, v92, 8, v36
    v_cmpx_gt_u32 vcc, -2, v20
    ds_add_rtn_u32 v44, v36, v114
    s_mov_b64 exec, -1
    v_cmp_ne_u32 vcc, -1, v21
    v_lshrrev_b32 v120, 18, v20
    v_bfe_u32 v128, v20, 6, 12
    v_add_u32 v128, v128, v72
    v_and_b32 v60, 15, v20
    v_lshl_add_u32 v60, v60, 1, s80
    v_mad_i32_i24 v92, v92, -7, 28
    s_cbranch_vccnz K2_CX
K2_C1:
    s_mov_b64 exec, 1
    ds_add_u32 v111, v114 offset:4
    s_mov_b64 exec, -1
    v_lshrrev_b32 v116, 18, v16
    v_bfe_u32 v124, v16, 6, 12
    v_add_u32 v124, v124, v72
    v_and_b32 v56, 15, v16
    v_lshl_add_u32 v56, v56, 1, s80
    v_mad_i32_i24 v88, v88, -7, 28
    v_lshrrev_b32 v117, 18, v17
    v_bfe_u32 v125, v17, 6, 12
    v_add_u32 v125, v125, v72
    v_and_b32 v57, 15, v17
    v_lshl_add_u32 v57, v57, 1, s80
    v_mad_i32_i24 v89, v89, -7, 28
    v_lshrrev_b32 v118, 18, v18
    v_bfe_u32 v126, v18, 6, 12
    v_add_u32 v126, v126, v72
    v_and_b32 v58, 15, v18
    v_lshl_add_u32 v58, v58, 1, s80
    v_mad_i32_i24 v90, v90, -7, 28
    v_lshrrev_b32 v119, 18, v19
    v_bfe_u32 v127, v19, 6, 12
    v_add_u32 v127, v127, v72
    v_and_b32 v59, 15, v19
    v_lshl_add_u32 v59, v59, 1, s80
    v_mad_i32_i24 v91, v91, -7, 28
K2_SB1:
    ds_read_b64 v[108:109], v111
    ds_read_u16 v26, v76 offset:0
    ds_read_u16 v27, v76 offset:256
    ds_read_u16 v28, v76 offset:512
    ds_read_u16 v29, v76 offset:768
    ds_read_u16 v30, v76 offset:1024
    s_waitcnt lgkmcnt(0)
    v_readfirstlane_b32 s66, v109
    v_add_u32 v26, v26, v73
    s_cmp_lt_u32 s66, 8
    s_cbranch_scc1 K2_SB1
    v_add3_u32 v27, v26, v27, v73
    v_add3_u32 v28, v27, v28, v73
    v_lshl_or_b32 v31, v26, 7, v27
    v_add3_u32 v29, v28, v29, v73
    v_lshl_or_b32 v31, v31, 7, v28
    v_readfirstlane_b32 s82, v108
    v_lshl_or_b32 v31, v31, 7, v29
    ds_bpermute_b32 v96, v32, v31
    ds_bpermute_b32 v97, v33, v31
    ds_bpermute_b32 v98, v34, v31
    ds_bpermute_b32 v99, v35, v31
    ds_bpermute_b32 v100, v36, v31
    v_add_u32 v30, v29, v30
    v_cmp_lt_u32 vcc, 0x7f, v29
    v_max_u32 v105, 24, v30
    v_add_u32 v105, -21, v105
    v_and_b32 v105, -4, v105
    s_or_b32 s82, s82, s70
    s_or_b32 s82, s82, vcc_lo
    v_add_u32_dpp v107, v105, v105 row_shr:1 row_mask:0xf bank_mask:0xf bound_ctrl:0
    s_or_b32 s82, s82, vcc_hi
    v_add_u32 v30, v30, v73
    v_add_u32_dpp v107, v107, v107 row_shr:2 row_mask:0xf bank_mask:0xf bound_ctrl:0
    s_cmp_lg_u32 s82, 0
    s_cbranch_scc1 K2_BAD
    v_add_u32_dpp v107, v107, v107 row_shr:4 row_mask:0xf bank_mask:0xf bound_ctrl:0
    s_waitcnt lgkmcnt(0)
    v_bfe_u32 v96, v96, v88, 7
    v_add_u32_sdwa v96, v96, v40 dst_sel:DWORD dst_unused:UNUSED_PAD src0_sel:DWORD src1_sel:WORD_0
    v_add_u32_sdwa v88, v96, v40 dst_sel:DWORD dst_unused:UNUSED_PAD src0_sel:DWORD src1_sel:WORD_1
    v_lshrrev_b32 v64, 2, v96
    v_mad_u32_u24 v88, v64, v74, v88
    v_lshl_add_u32 v64, v88, 5, v56
    v_lshl_add_u32 v88, v88, 2, s79
    v_cmpx_gt_u32 vcc, 24, v96
    ds_write2st64_b32 v88, v116, v124 offset0:0 offset1:25
    ds_write_b16 v64, v75
    s_mov_b64 exec, -1
    v_bfe_u32 v97, v97, v89, 7
    v_add_u32_sdwa v97, v97, v41 dst_sel:DWORD dst_unused:UNUSED_PAD src0_sel:DWORD src1_sel:WORD_0
    v_add_u32_sdwa v89, v97, v41 dst_sel:DWORD dst_unused:UNUSED_PAD src0_sel:DWORD src1_sel:WORD_1
    v_lshrrev_b32 v65, 2, v97
    v_mad_u32_u24 v89, v65, v74, v89
    v_lshl_add_u32 v65, v89, 5, v57
    v_lshl_add_u32 v89, v89, 2, s79
    v_cmpx_gt_u32 vcc, 24, v97
    ds_write2st64_b32 v89, v117, v125 offset0:0 offset1:25
    ds_write_b16 v65, v75
    s_mov_b64 exec, -1
    v_bfe_u32 v98, v98, v90, 7
    v_add_u32_sdwa v98, v98, v42 dst_sel:DWORD dst_unused:UNUSED_PAD src0_sel:DWORD src1_sel:WORD_0
    v_add_u32_sdwa v90, v98, v42 dst_sel:DWORD dst_unused:UNUSED_PAD src0_sel:DWORD src1_sel:WORD_1
    v_lshrrev_b32 v66, 2, v98
    v_mad_u32_u24 v90, v66, v74, v90
    v_lshl_add_u32 v66, v90, 5, v58
    v_lshl_add_u32 v90, v90, 2, s79
    v_cmpx_gt_u32 vcc, 24, v98
    ds_write2st64_b32 v90, v118, v126 offset0:0 offset1:25
    ds_write_b16 v66, v75
    s_mov_b64 exec, -1
    v_bfe_u32 v99, v99, v91, 7
    v_add_u32_sdwa v99, v99, v43 dst_sel:DWORD dst_unused:UNUSED_PAD src0_sel:DWORD src1_sel:WORD_0
    v_add_u32_sdwa v91, v99, v43 dst_sel:DWORD dst_unused:UNUSED_PAD src0_sel:DWORD src1_sel:WORD_1
    v_lshrrev_b32 v67, 2, v99
    v_mad_u32_u24 v91, v67, v74, v91
    v_lshl_add_u32 v67, v91, 5, v59
    v_lshl_add_u32 v91, v91, 2, s79
    v_cmpx_gt_u32 vcc, 24, v99
    ds_write2st64_b32 v91, v119, v127 offset0:0 offset1:25
    ds_write_b16 v67, v75
    s_mov_b64 exec, -1
    s_cmp_eq_u32 s81, 0
    s_cbranch_scc1 K2_S0
    v_bfe_u32 v100, v100, v92, 7
    v_add_u32_sdwa v100, v100, v44 dst_sel:DWORD dst_unused:UNUSED_PAD src0_sel:DWORD src1_sel:WORD_0
    v_add_u32_sdwa v92, v100, v44 dst_sel:DWORD dst_unused:UNUSED_PAD src0_sel:DWORD src1_sel:WORD_1
    v_lshrrev_b32 v68, 2, v100
    v_mad_u32_u24 v92, v68, v74, v92
    v_lshl_add_u32 v68, v92, 5, v60
    v_lshl_add_u32 v92, v92, 2, s79
    v_cmpx_gt_u32 vcc, 24, v100
    ds_write2st64_b32 v92, v120, v128 offset0:0 offset1:25
    ds_write_b16 v68, v75
    s_mov_b64 exec, -1
    s_cmp_lg_u32 s81, 1
    s_cbranch_scc1 K2_SY
K2_S0:
    s_mov_b64 exec, 1
    ds_add_u32 v111, v114 offset:8
    s_mov_b64 exec, -1
    ds_write_b32 v76, v30 offset:1536
    v_add_u32_dpp v107, v107, v107 row_shr:8 row_mask:0xf bank_mask:0xf bound_ctrl:0
    s_mov_b32 s53, 9
    s_nop 0
    v_add_u32_dpp v107, v107, v107 row_bcast:15 row_mask:0xa bank_mask:0xf
    s_nop 1
    v_add_u32_dpp v107, v107, v107 row_bcast:31 row_mask:0xc bank_mask:0xf
    v_sub_u32 v108, v107, v105
    v_readlane_b32 s83, v107, 63
    ds_bpermute_b32 v48, v32, v108
    ds_bpermute_b32 v49, v33, v108
    ds_bpermute_b32 v50, v34, v108
    ds_bpermute_b32 v51, v35, v108
    ds_bpermute_b32 v52, v36, v108
    s_cmp_lg_u32 s26, 0
    s_cbranch_scc1 K2_NE1
K2_SB2a:
    ds_read_b32 v109, v111 offset:8
    ds_read_b32 v136, v10 offset:0
    ds_read_b32 v138, v10 offset:32
    ds_read_b32 v140, v10 offset:64
    ds_read_b32 v142, v10 offset:96
    ds_read_b32 v12, v4
    s_waitcnt lgkmcnt(0)
    v_readfirstlane_b32 s66, v109
    s_nop 0
    s_cmp_lt_u32 s66, 12
    s_cbranch_scc1 K2_SB2a
    s_cmp_lg_u32 s25, 0
    s_cbranch_scc1 K2_FL1
    s_cmp_lt_u32 s61, s53
    s_cselect_b32 s86, 320000, 0
    s_cselect_b32 m0, s59, 0x28000
    s_add_u32 s61, s61, 4
    buffer_load_dwordx4 v[12:13], s[84:87], 0 idxen offen lds
    s_mov_b32 m0, s57
    s_add_u32 s59, s59, 4096
K2_FL1:
    buffer_load_dwordx4 v[136:137], s[32:35], s28 idxen offen offset:0 lds
    buffer_load_dwordx4 v[138:139], s[32:35], s29 idxen offen offset:1024 lds
    buffer_load_dwordx4 v[140:141], s[32:35], s30 idxen offen offset:2048 lds
    buffer_load_dwordx4 v[142:143], s[32:35], s31 idxen offen offset:3072 lds
K2_NE1:
    v_readlane_b32 s76, v108, 12
    v_readlane_b32 s77, v108, 16
    v_readlane_b32 s68, v108, 24
    v_readlane_b32 s69, v108, 28
    s_add_u32 s88, s83, 95
    s_lshr_b32 s88, s88, 5
    s_mul_i32 s88, s88, 171
    s_lshr_b32 s88, s88, 9
    s_add_u32 s89, s76, 31
    s_lshr_b32 s89, s89, 5
    s_max_u32 s88, s88, s89
    s_lshr_b32 s89, s77, 5
    s_min_u32 s88, s88, s89
    s_lshl_b32 s88, s88, 5
    s_max_u32 s76, s88, s76
    s_sub_u32 s88, s83, s76
    s_add_u32 s88, s88, 63
    s_lshr_b32 s88, s88, 6
    s_sub_u32 s89, s68, s76
    s_add_u32 s89, s89, 31
    s_lshr_b32 s89, s89, 5
    s_max_u32 s88, s88, s89
    s_sub_u32 s89, s69, s76
    s_lshr_b32 s89, s89, 5
    s_min_u32 s88, s88, s89
    s_lshl_b32 s88, s88, 5
    s_add_u32 s88, s88, s76
    s_max_u32 s77, s88, s68
    s_sub_u32 s88, s83, 224
    s_max_i32 s77, s77, s88
    s_min_u32 s77, s77, s69
    s_add_u32 s53, s76, 319
    s_lshr_b32 s53, s53, 5
    s_sub_u32 s90, s77, s76
    s_add_u32 s90, s90, 319
    s_lshr_b32 s90, s90, 5
    s_sub_u32 s91, s83, s77
    s_add_u32 s91, s91, 319
    s_lshr_b32 s91, s91, 5
    s_sub_u32 s88, 776, s76
    s_sub_u32 s89, 1288, s77
    s_add_u32 s76, s76, 24
    s_add_u32 s77, s77, 24
    s_max_u32 s92, s90, s53
    s_max_u32 s92, s92, s91
    s_cmp_gt_u32 s92, 16
    s_cbranch_scc1 K2_BAD
    v_mov_b32 v106, s91
    ds_write_b32 v111, v106 offset:16
    s_cmp_eq_u32 s26, 1
    s_cselect_b32 s53, s90, s53
    v_mov_b32 v105, 264
    s_waitcnt lgkmcnt(0)
    v_mov_b32 v106, s88
    v_mov_b32 v107, s89
    v_add_u32 v48, v48, v96
    v_cmp_gt_u32 vcc, s76, v48
    v_cmp_gt_u32 s[68:69], s77, v48
    v_cmpx_le_u32 s[82:83], 24, v96
    v_cmpx_gt_u32 s[82:83], -2, v16
    v_cndmask_b32 v64, v107, v106, s[68:69]
    v_cndmask_b32 v64, v64, v105, vcc
    v_add_u32 v48, v48, v64
    v_lshl_add_u32 v56, v48, 5, v56
    v_lshl_add_u32 v48, v48, 2, s79
    ds_write2st64_b32 v48, v116, v124 offset0:0 offset1:25
    ds_write_b16 v56, v75
    s_mov_b64 exec, -1
    v_add_u32 v49, v49, v97
    v_cmp_gt_u32 vcc, s76, v49
    v_cmp_gt_u32 s[68:69], s77, v49
    v_cmpx_le_u32 s[82:83], 24, v97
    v_cmpx_gt_u32 s[82:83], -2, v17
    v_cndmask_b32 v65, v107, v106, s[68:69]
    v_cndmask_b32 v65, v65, v105, vcc
    v_add_u32 v49, v49, v65
    v_lshl_add_u32 v57, v49, 5, v57
    v_lshl_add_u32 v49, v49, 2, s79
    ds_write2st64_b32 v49, v117, v125 offset0:0 offset1:25
    ds_write_b16 v57, v75
    s_mov_b64 exec, -1
    v_add_u32 v50, v50, v98
    v_cmp_gt_u32 vcc, s76, v50
    v_cmp_gt_u32 s[68:69], s77, v50
    v_cmpx_le_u32 s[82:83], 24, v98
    v_cmpx_gt_u32 s[82:83], -2, v18
    v_cndmask_b32 v66, v107, v106, s[68:69]
    v_cndmask_b32 v66, v66, v105, vcc
    v_add_u32 v50, v50, v66
    v_lshl_add_u32 v58, v50, 5, v58
    v_lshl_add_u32 v50, v50, 2, s79
    ds_write2st64_b32 v50, v118, v126 offset0:0 offset1:25
    ds_write_b16 v58, v75
    s_mov_b64 exec, -1
    v_add_u32 v51, v51, v99
    v_cmp_gt_u32 vcc, s76, v51
    v_cmp_gt_u32 s[68:69], s77, v51
    v_cmpx_le_u32 s[82:83], 24, v99
    v_cmpx_gt_u32 s[82:83], -2, v19
    v_cndmask_b32 v67, v107, v106, s[68:69]
    v_cndmask_b32 v67, v67, v105, vcc
    v_add_u32 v51, v51, v67
    v_lshl_add_u32 v59, v51, 5, v59
    v_lshl_add_u32 v51, v51, 2, s79
    ds_write2st64_b32 v51, v119, v127 offset0:0 offset1:25
    ds_write_b16 v59, v75
    s_mov_b64 exec, -1
    s_cmp_eq_u32 s81, 0
    s_cbranch_scc1 K2_S1
    v_add_u32 v52, v52, v100
    v_cmp_gt_u32 vcc, s76, v52
    v_cmp_gt_u32 s[68:69], s77, v52
    v_cmpx_le_u32 s[82:83], 24, v100
    v_cmpx_gt_u32 s[82:83], -2, v20
    v_cndmask_b32 v68, v107, v106, s[68:69]
    v_cndmask_b32 v68, v68, v105, vcc
    v_add_u32 v52, v52, v68
    v_lshl_add_u32 v60, v52, 5, v60
    v_lshl_add_u32 v52, v52, 2, s79
    ds_write2st64_b32 v52, v120, v128 offset0:0 offset1:25
    ds_write_b16 v60, v75
    s_mov_b64 exec, -1
    s_cmp_lg_u32 s81, 1
    s_cbranch_scc1 K2_SX
K2_S1:
    s_mov_b64 exec, 1
    ds_add_u32 v111, v114 offset:40
    s_mov_b64 exec, -1
    s_cmp_eq_u32 s26, 0
    s_cbranch_scc1 K2_NE2
K2_SB2b:
    ds_read_b32 v109, v111 offset:8
    ds_read_b32 v136, v10 offset:0
    ds_read_b32 v138, v10 offset:32
    ds_read_b32 v140, v10 offset:64
    ds_read_b32 v142, v10 offset:96
    ds_read_b32 v12, v4
    s_waitcnt lgkmcnt(0)
    v_readfirstlane_b32 s66, v109
    s_nop 0
    s_cmp_lt_u32 s66, 12
    s_cbranch_scc1 K2_SB2b
    s_cmp_lg_u32 s25, 0
    s_cbranch_scc1 K2_FL2
    s_cmp_lt_u32 s61, s53
    s_cselect_b32 s86, 320000, 0
    s_cselect_b32 m0, s59, 0x28000
    s_add_u32 s61, s61, 4
    buffer_load_dwordx4 v[12:13], s[84:87], 0 idxen offen lds
    s_mov_b32 m0, s57
    s_add_u32 s59, s59, 4096
K2_FL2:
    buffer_load_dwordx4 v[136:137], s[32:35], s28 idxen offen offset:0 lds
    buffer_load_dwordx4 v[138:139], s[32:35], s29 idxen offen offset:1024 lds
    buffer_load_dwordx4 v[140:141], s[32:35], s30 idxen offen offset:2048 lds
    buffer_load_dwordx4 v[142:143], s[32:35], s31 idxen offen offset:3072 lds
K2_NE2:
    s_branch K2_QD
K2_HQ:
    v_lshrrev_b32 v77, 5, v1
    s_lshl_b32 s66, s25, 11
    v_and_b32 v105, 3, v1
    v_and_b32 v106, 4, v1
    v_lshl_or_b32 v105, v106, 1, v105
    v_bfe_u32 v106, v1, 3, 1
    v_lshl_or_b32 v105, v106, 2, v105
    v_xor_b32 v106, v105, v77
    v_lshlrev_b32 v106, 4, v106
    v_lshl_add_u32 v132, v105, 8, v106
    v_and_b32 v106, 16, v1
    v_lshl_add_u32 v132, v106, 10, v132
    v_add_u32 v132, 53248, v132
    s_add_u32 s67, s66, 57344
    v_add_u32 v107, s67, v6
    s_mov_b32 s48, s14
    s_mov_b32 s49, s15
    s_mov_b32 s50, 512
    s_mov_b32 s51, 0x00020000
    v_and_b32 v108, 1, v1
    v_and_b32 v109, 30, v1
    v_lshl_add_u32 v108, v108, 6, v109
    s_lshl_b32 s66, s25, 14
    s_add_u32 s76, s66, 4259840
    s_add_u32 s77, s76, 4096
    s_add_u32 s78, s76, 8192
    s_add_u32 s79, s76, 12288
    s_mov_b32 s68, 0xbfb8aa3b
    s_mov_b32 s69, 0xbfb8aa3b
    buffer_load_ushort v112, v108, s[48:51], s58 offen
    buffer_load_ushort v113, v108, s[48:51], s58 offen offset:32
    buffer_load_dwordx4 v[80:83], v6, s[40:43], s72 offen
    buffer_load_dwordx4 v[84:87], v6, s[40:43], s72 offen offset:1024
    s_mov_b32 s53, 9
    s_waitcnt lgkmcnt(0)
    s_barrier
    buffer_load_dwordx4 v[32:35], v6, s[40:43], s76 offen offset:0
    buffer_load_dwordx4 v[64:67], v6, s[40:43], s78 offen offset:0
    buffer_load_dwordx4 v[36:39], v6, s[40:43], s76 offen offset:1024
    buffer_load_dwordx4 v[68:71], v6, s[40:43], s78 offen offset:1024
    buffer_load_dwordx4 v[40:43], v6, s[40:43], s76 offen offset:2048
    buffer_load_dwordx4 v[72:75], v6, s[40:43], s78 offen offset:2048
    buffer_load_dwordx4 v[44:47], v6, s[40:43], s76 offen offset:3072
    buffer_load_dwordx4 v[76:79], v6, s[40:43], s78 offen offset:3072
    buffer_load_dwordx4 v[48:51], v6, s[40:43], s77 offen offset:0
    buffer_load_dwordx4 v[96:99], v6, s[40:43], s79 offen offset:0
    buffer_load_dwordx4 v[52:55], v6, s[40:43], s77 offen offset:1024
    buffer_load_dwordx4 v[100:103], v6, s[40:43], s79 offen offset:1024
    buffer_load_dwordx4 v[56:59], v6, s[40:43], s77 offen offset:2048
    buffer_load_dwordx4 v[88:91], v6, s[40:43], s79 offen offset:2048
    buffer_load_dwordx4 v[60:63], v6, s[40:43], s77 offen offset:3072
    buffer_load_dwordx4 v[92:95], v6, s[40:43], s79 offen offset:3072
    s_mov_b64 exec, 1
    ds_add_u32 v111, v114 offset:8
    s_mov_b64 exec, -1
    s_waitcnt vmcnt(20)
    s_mov_b64 exec, 1
    ds_add_u32 v111, v114 offset:12
    s_mov_b64 exec, -1
K2_HS:
    ds_read_b32 v108, v111 offset:12
    s_waitcnt lgkmcnt(0)
    v_readfirstlane_b32 s66, v108
    s_nop 0
    s_cmp_lt_u32 s66, 4
    s_cbranch_scc1 K2_HS
    ds_read_b128 v[144:147], v132 offset:0
    v_xor_b32 v133, 32, v132
    ds_read_b128 v[148:151], v133 offset:0
    v_xor_b32 v133, 64, v132
    ds_read_b128 v[152:155], v133 offset:0
    v_xor_b32 v133, 96, v132
    ds_read_b128 v[156:159], v133 offset:0
    s_setprio 3
    s_waitcnt vmcnt(16)
    v_lshlrev_b32 v112, 16, v112
    v_lshlrev_b32 v113, 16, v113
    v_mul_f32 v112, s68, v112
    v_mul_f32 v113, s68, v113
    s_waitcnt vmcnt(14) lgkmcnt(3)
    v_mfma_f32_32x32x16_bf16 v[16:31], v[144:147], v[32:35], 0
    v_mfma_f32_32x32x16_bf16 v[116:131], v[144:147], v[64:67], 0
    v_xor_b32 v133, 128, v132
    ds_read_b128 v[144:147], v133 offset:0
    s_waitcnt vmcnt(12) lgkmcnt(3)
    v_mfma_f32_32x32x16_bf16 v[16:31], v[148:151], v[36:39], v[16:31]
    v_mfma_f32_32x32x16_bf16 v[116:131], v[148:151], v[68:71], v[116:131]
    v_xor_b32 v133, 160, v132
    ds_read_b128 v[148:151], v133 offset:0
    s_waitcnt vmcnt(10) lgkmcnt(3)
    v_mfma_f32_32x32x16_bf16 v[16:31], v[152:155], v[40:43], v[16:31]
    v_mfma_f32_32x32x16_bf16 v[116:131], v[152:155], v[72:75], v[116:131]
    v_xor_b32 v133, 192, v132
    ds_read_b128 v[152:155], v133 offset:0
    s_waitcnt vmcnt(8) lgkmcnt(3)
    v_mfma_f32_32x32x16_bf16 v[16:31], v[156:159], v[44:47], v[16:31]
    v_mfma_f32_32x32x16_bf16 v[116:131], v[156:159], v[76:79], v[116:131]
    v_xor_b32 v133, 224, v132
    ds_read_b128 v[156:159], v133 offset:0
    s_waitcnt vmcnt(6) lgkmcnt(3)
    v_mfma_f32_32x32x16_bf16 v[16:31], v[144:147], v[48:51], v[16:31]
    v_mfma_f32_32x32x16_bf16 v[116:131], v[144:147], v[96:99], v[116:131]
    ds_read_b128 v[144:147], v132 offset:32768
    s_waitcnt vmcnt(4) lgkmcnt(3)
    v_mfma_f32_32x32x16_bf16 v[16:31], v[148:151], v[52:55], v[16:31]
    v_mfma_f32_32x32x16_bf16 v[116:131], v[148:151], v[100:103], v[116:131]
    v_xor_b32 v133, 32, v132
    ds_read_b128 v[148:151], v133 offset:32768
    s_waitcnt vmcnt(2) lgkmcnt(3)
    v_mfma_f32_32x32x16_bf16 v[16:31], v[152:155], v[56:59], v[16:31]
    v_mfma_f32_32x32x16_bf16 v[116:131], v[152:155], v[88:91], v[116:131]
    v_xor_b32 v133, 64, v132
    ds_read_b128 v[152:155], v133 offset:32768
    s_waitcnt vmcnt(0) lgkmcnt(3)
    v_mfma_f32_32x32x16_bf16 v[16:31], v[156:159], v[60:63], v[16:31]
    v_mfma_f32_32x32x16_bf16 v[116:131], v[156:159], v[92:95], v[116:131]
    v_xor_b32 v133, 96, v132
    ds_read_b128 v[156:159], v133 offset:32768
    s_nop 10
    v_fma_f32 v16, v16, s68, v112
    v_fma_f32 v17, v17, s68, v112
    v_fma_f32 v18, v18, s68, v112
    v_fma_f32 v19, v19, s68, v112
    v_fma_f32 v20, v20, s68, v112
    v_fma_f32 v21, v21, s68, v112
    v_fma_f32 v22, v22, s68, v112
    v_fma_f32 v23, v23, s68, v112
    v_cvt_pk_bf16_f32 v160, v16, v17
    v_cvt_pk_bf16_f32 v161, v18, v19
    v_cvt_pk_bf16_f32 v162, v20, v21
    v_cvt_pk_bf16_f32 v163, v22, v23
    ds_write_b128 v107, v[160:163] offset:0
    v_fma_f32 v116, v116, s68, v113
    v_fma_f32 v117, v117, s68, v113
    v_fma_f32 v118, v118, s68, v113
    v_fma_f32 v119, v119, s68, v113
    v_fma_f32 v120, v120, s68, v113
    v_fma_f32 v121, v121, s68, v113
    v_fma_f32 v122, v122, s68, v113
    v_fma_f32 v123, v123, s68, v113
    v_cvt_pk_bf16_f32 v164, v116, v117
    v_cvt_pk_bf16_f32 v165, v118, v119
    v_cvt_pk_bf16_f32 v166, v120, v121
    v_cvt_pk_bf16_f32 v167, v122, v123
    ds_write_b128 v107, v[164:167] offset:1024
    v_fma_f32 v24, v24, s68, v112
    v_fma_f32 v25, v25, s68, v112
    v_fma_f32 v26, v26, s68, v112
    v_fma_f32 v27, v27, s68, v112
    v_fma_f32 v28, v28, s68, v112
    v_fma_f32 v29, v29, s68, v112
    v_fma_f32 v30, v30, s68, v112
    v_fma_f32 v31, v31, s68, v112
    s_waitcnt lgkmcnt(0)
    v_cvt_pk_bf16_f32 v160, v24, v25
    v_cvt_pk_bf16_f32 v161, v26, v27
    v_cvt_pk_bf16_f32 v162, v28, v29
    v_cvt_pk_bf16_f32 v163, v30, v31
    ds_write_b128 v107, v[160:163] offset:16384
    v_fma_f32 v124, v124, s68, v113
    v_fma_f32 v125, v125, s68, v113
    v_fma_f32 v126, v126, s68, v113
    v_fma_f32 v127, v127, s68, v113
    v_fma_f32 v128, v128, s68, v113
    v_fma_f32 v129, v129, s68, v113
    v_fma_f32 v130, v130, s68, v113
    v_fma_f32 v131, v131, s68, v113
    v_cvt_pk_bf16_f32 v164, v124, v125
    v_cvt_pk_bf16_f32 v165, v126, v127
    v_cvt_pk_bf16_f32 v166, v128, v129
    v_cvt_pk_bf16_f32 v167, v130, v131
    ds_write_b128 v107, v[164:167] offset:17408
    s_mov_b64 exec, 1
    ds_add_u32 v111, v114 offset:36
    s_mov_b64 exec, -1
    s_setprio 0
K2_SB2h:
    ds_read_b32 v109, v111 offset:8
    ds_read_b32 v136, v10 offset:0
    ds_read_b32 v138, v10 offset:32
    ds_read_b32 v140, v10 offset:64
    ds_read_b32 v142, v10 offset:96
    ds_read_b32 v12, v4
    s_waitcnt lgkmcnt(0)
    v_readfirstlane_b32 s66, v109
    s_nop 0
    s_cmp_lt_u32 s66, 12
    s_cbranch_scc1 K2_SB2h
    s_cmp_lg_u32 s25, 0
    s_cbranch_scc1 K2_FL3
    s_cmp_lt_u32 s61, s53
    s_cselect_b32 s86, 320000, 0
    s_cselect_b32 m0, s59, 0x28000
    s_add_u32 s61, s61, 4
    buffer_load_dwordx4 v[12:13], s[84:87], 0 idxen offen lds
    s_mov_b32 m0, s57
    s_add_u32 s59, s59, 4096
K2_FL3:
    buffer_load_dwordx4 v[136:137], s[32:35], s28 idxen offen offset:0 lds
    buffer_load_dwordx4 v[138:139], s[32:35], s29 idxen offen offset:1024 lds
    buffer_load_dwordx4 v[140:141], s[32:35], s30 idxen offen offset:2048 lds
    buffer_load_dwordx4 v[142:143], s[32:35], s31 idxen offen offset:3072 lds
    v_mfma_f32_32x32x16_bf16 v[16:31], v[144:147], v[32:35], 0
    v_mfma_f32_32x32x16_bf16 v[116:131], v[144:147], v[64:67], 0
    v_xor_b32 v133, 128, v132
    ds_read_b128 v[144:147], v133 offset:32768
    v_mfma_f32_32x32x16_bf16 v[16:31], v[148:151], v[36:39], v[16:31]
    v_mfma_f32_32x32x16_bf16 v[116:131], v[148:151], v[68:71], v[116:131]
    v_xor_b32 v133, 160, v132
    ds_read_b128 v[148:151], v133 offset:32768
    v_mfma_f32_32x32x16_bf16 v[16:31], v[152:155], v[40:43], v[16:31]
    v_mfma_f32_32x32x16_bf16 v[116:131], v[152:155], v[72:75], v[116:131]
    v_xor_b32 v133, 192, v132
    ds_read_b128 v[152:155], v133 offset:32768
    v_mfma_f32_32x32x16_bf16 v[16:31], v[156:159], v[44:47], v[16:31]
    v_mfma_f32_32x32x16_bf16 v[116:131], v[156:159], v[76:79], v[116:131]
    v_xor_b32 v133, 224, v132
    ds_read_b128 v[156:159], v133 offset:32768
    s_waitcnt lgkmcnt(3)
    v_mfma_f32_32x32x16_bf16 v[16:31], v[144:147], v[48:51], v[16:31]
    v_mfma_f32_32x32x16_bf16 v[116:131], v[144:147], v[96:99], v[116:131]
    s_waitcnt lgkmcnt(2)
    v_mfma_f32_32x32x16_bf16 v[16:31], v[148:151], v[52:55], v[16:31]
    v_mfma_f32_32x32x16_bf16 v[116:131], v[148:151], v[100:103], v[116:131]
    s_waitcnt lgkmcnt(1)
    v_mfma_f32_32x32x16_bf16 v[16:31], v[152:155], v[56:59], v[16:31]
    v_mfma_f32_32x32x16_bf16 v[116:131], v[152:155], v[88:91], v[116:131]
    s_waitcnt lgkmcnt(0)
    v_mfma_f32_32x32x16_bf16 v[16:31], v[156:159], v[60:63], v[16:31]
    v_mfma_f32_32x32x16_bf16 v[116:131], v[156:159], v[92:95], v[116:131]
    s_nop 10
    v_fma_f32 v16, v16, s68, v112
    v_fma_f32 v17, v17, s68, v112
    v_fma_f32 v18, v18, s68, v112
    v_fma_f32 v19, v19, s68, v112
    v_fma_f32 v20, v20, s68, v112
    v_fma_f32 v21, v21, s68, v112
    v_fma_f32 v22, v22, s68, v112
    v_fma_f32 v23, v23, s68, v112
    v_cvt_pk_bf16_f32 v88, v16, v17
    v_cvt_pk_bf16_f32 v89, v18, v19
    v_cvt_pk_bf16_f32 v90, v20, v21
    v_cvt_pk_bf16_f32 v91, v22, v23
    ds_write_b128 v107, v[88:91] offset:32768
    v_fma_f32 v116, v116, s68, v113
    v_fma_f32 v117, v117, s68, v113
    v_fma_f32 v118, v118, s68, v113
    v_fma_f32 v119, v119, s68, v113
    v_fma_f32 v120, v120, s68, v113
    v_fma_f32 v121, v121, s68, v113
    v_fma_f32 v122, v122, s68, v113
    v_fma_f32 v123, v123, s68, v113
    v_cvt_pk_bf16_f32 v92, v116, v117
    v_cvt_pk_bf16_f32 v93, v118, v119
    v_cvt_pk_bf16_f32 v94, v120, v121
    v_cvt_pk_bf16_f32 v95, v122, v123
    ds_write_b128 v107, v[92:95] offset:33792
    s_mov_b64 exec, 1
    ds_add_u32 v111, v114 offset:44
    s_mov_b64 exec, -1
K2_QD:
    v_mov_b32 v167, v111
    v_mov_b32 v166, v4
    v_mov_b32 v1, v110
    v_mov_b32 v165, -1
    ds_read_b32 v136, v10 offset:128
    ds_read_b32 v138, v10 offset:160
    ds_read_b32 v140, v10 offset:192
    ds_read_b32 v142, v10 offset:224
    ds_read_b128 v[108:111], v7
    v_mov_b32 v64, 0
    v_mov_b32 v65, 0
    v_mov_b32 v66, 0
    v_mov_b32 v67, 0
    v_mov_b32 v68, 0
    v_mov_b32 v69, 0
    v_mov_b32 v70, 0
    v_mov_b32 v71, 0
    v_mov_b32 v72, 0
    v_mov_b32 v73, 0
    v_mov_b32 v74, 0
    v_mov_b32 v75, 0
    v_mov_b32 v76, 0
    v_mov_b32 v77, 0
    v_mov_b32 v78, 0
    v_mov_b32 v79, 0
    v_mov_b32 v14, 0
    v_mov_b32 v15, 0
    s_cmp_lg_u32 s25, 0
    s_waitcnt vmcnt(0)
    s_cbranch_scc1 K2_NF
    s_waitcnt vmcnt(0)
    ds_write_b32 v166, v165
    ds_read_b32 v12, v11 offset:512
K2_NF:
    ds_read_b64_tr_b16 v[16:17], v2 offset:0
    ds_read_b64_tr_b16 v[18:19], v2 offset:128
    ds_read_b64_tr_b16 v[20:21], v2 offset:256
    ds_read_b64_tr_b16 v[22:23], v2 offset:384
    ds_read_b64_tr_b16 v[24:25], v2 offset:512
    ds_read_b64_tr_b16 v[26:27], v2 offset:640
    ds_read_b64_tr_b16 v[28:29], v2 offset:768
    ds_read_b64_tr_b16 v[30:31], v2 offset:896
    ds_read_b64_tr_b16 v[116:117], v3 offset:0
    ds_read_b64_tr_b16 v[118:119], v3 offset:128
    ds_read_b64_tr_b16 v[120:121], v3 offset:256
    ds_read_b64_tr_b16 v[122:123], v3 offset:384
    ds_read_b64_tr_b16 v[124:125], v3 offset:512
    ds_read_b64_tr_b16 v[126:127], v3 offset:640
    ds_read_b64_tr_b16 v[128:129], v3 offset:768
    ds_read_b64_tr_b16 v[130:131], v3 offset:896
    s_waitcnt lgkmcnt(0)
    buffer_load_dwordx4 v[136:137], s[32:35], s28 idxen offen offset:0 lds
    buffer_load_dwordx4 v[138:139], s[32:35], s29 idxen offen offset:1024 lds
    buffer_load_dwordx4 v[140:141], s[32:35], s30 idxen offen offset:2048 lds
    buffer_load_dwordx4 v[142:143], s[32:35], s31 idxen offen offset:3072 lds
    s_sub_u32 s67, s25, 1
    s_cmp_ge_u32 s67, 2
    s_cbranch_scc1 K2_F2
    s_cmp_lt_u32 s61, s53
    s_cselect_b32 s86, 320000, 0
    s_cselect_b32 m0, s59, 0x28000
    s_add_u32 s61, s61, 4
    buffer_load_dwordx4 v[12:13], s[84:87], 0 idxen offen lds
    s_mov_b32 m0, s57
    s_add_u32 s59, s59, 4096
K2_F2:
    s_cmp_eq_u32 s26, 2
    s_cbranch_scc1 K2_NBQ
LW1:
    ds_read_b32 v164, v167 offset:36
    ds_read_b128 v[88:91], v115 offset:8192
    ds_read_b128 v[92:95], v115 offset:9216
    s_waitcnt lgkmcnt(0)
    v_readfirstlane_b32 s66, v164
    s_nop 0
    s_cmp_ge_u32 s66, 4
    s_cbranch_scc1 LX1
    s_sleep 1
    s_branch LW1
LX1:
K2_NBQ:
K2_WA:
    ds_read_b32 v164, v11 offset:0
    s_waitcnt lgkmcnt(0)
    v_readfirstlane_b32 s66, v164
    s_nop 0
    s_cmp_eq_u32 s66, -1
    s_cbranch_scc1 K2_XA
    s_sleep 1
    s_branch K2_WA
K2_XA:
    ds_read_b128 v[104:107], v1
    s_setprio 3
    s_waitcnt lgkmcnt(0)
    v_mfma_f32_32x32x16_bf16 v[16:31], v[104:107], v[80:83], v[16:31]
    v_mfma_f32_32x32x16_bf16 v[16:31], v[108:111], v[88:91], v[16:31]
    s_nop 10
    v_mfma_f32_32x32x16_bf16 v[32:47], v[104:107], v[84:87], v[116:131]
    v_exp_f32 v48, v16
    v_exp_f32 v49, v17
    ds_read_b32 v136, v10 offset:256
    ds_read_b32 v138, v10 offset:288
    ds_read_b32 v140, v10 offset:320
    ds_read_b32 v142, v10 offset:352
    v_exp_f32 v50, v18
    v_mfma_f32_32x32x16_bf16 v[32:47], v[108:111], v[92:95], v[32:47]
    v_exp_f32 v51, v19
    v_exp_f32 v52, v20
    v_exp_f32 v53, v21
    v_exp_f32 v54, v22
    v_exp_f32 v55, v23
    v_exp_f32 v56, v24
    v_exp_f32 v57, v25
    v_exp_f32 v58, v26
    v_exp_f32 v59, v27
    v_exp_f32 v60, v28
    v_exp_f32 v61, v29
    v_exp_f32 v62, v30
    v_exp_f32 v63, v31
    v_pk_add_f32 v[48:49], v[48:49], 1.0 op_sel_hi:[1,0]
    v_pk_add_f32 v[56:57], v[56:57], 1.0 op_sel_hi:[1,0]
    v_pk_fma_f32 v[16:17], v[16:17], v[50:51], v[16:17]
    v_pk_fma_f32 v[24:25], v[24:25], v[58:59], v[24:25]
    v_pk_fma_f32 v[16:17], v[18:19], v[48:49], v[16:17]
    v_pk_fma_f32 v[24:25], v[26:27], v[56:57], v[24:25]
    v_pk_fma_f32 v[48:49], v[48:49], v[50:51], v[48:49]
    v_pk_fma_f32 v[56:57], v[56:57], v[58:59], v[56:57]
    v_pk_fma_f32 v[16:17], v[16:17], v[52:53], v[16:17]
    v_pk_fma_f32 v[24:25], v[24:25], v[60:61], v[24:25]
    v_pk_fma_f32 v[16:17], v[20:21], v[48:49], v[16:17]
    v_pk_fma_f32 v[24:25], v[28:29], v[56:57], v[24:25]
    v_pk_fma_f32 v[48:49], v[48:49], v[52:53], v[48:49]
    v_pk_fma_f32 v[56:57], v[56:57], v[60:61], v[56:57]
    v_pk_fma_f32 v[16:17], v[16:17], v[54:55], v[16:17]
    v_pk_fma_f32 v[24:25], v[24:25], v[62:63], v[24:25]
    v_pk_fma_f32 v[16:17], v[22:23], v[48:49], v[16:17]
    v_pk_fma_f32 v[24:25], v[30:31], v[56:57], v[24:25]
    v_pk_fma_f32 v[48:49], v[48:49], v[54:55], v[48:49]
    v_pk_fma_f32 v[56:57], v[56:57], v[62:63], v[56:57]
    v_pk_fma_f32 v[14:15], v[48:49], v[56:57], v[14:15]
    v_rcp_f32 v48, v48
    v_rcp_f32 v49, v49
    v_rcp_f32 v56, v56
    v_rcp_f32 v57, v57
    v_pk_mul_f32 v[16:17], v[16:17], v[48:49]
    v_pk_mul_f32 v[24:25], v[24:25], v[56:57]
    v_cvt_pk_bf16_f32 v132, v16, v17
    v_cvt_pk_bf16_f32 v133, v24, v25
    v_exp_f32 v48, v32
    v_exp_f32 v49, v33
    ds_read_b64_tr_b16 v[112:113], v8
    ds_read_b64_tr_b16 v[114:115], v9
    ds_read_b128 v[108:111], v7 offset:1024
    v_exp_f32 v50, v34
    v_exp_f32 v51, v35
    v_exp_f32 v52, v36
    v_exp_f32 v53, v37
    v_exp_f32 v54, v38
    v_exp_f32 v55, v39
    v_exp_f32 v56, v40
    v_exp_f32 v57, v41
    v_exp_f32 v58, v42
    v_exp_f32 v59, v43
    v_exp_f32 v60, v44
    v_exp_f32 v61, v45
    v_exp_f32 v62, v46
    v_exp_f32 v63, v47
    v_pk_add_f32 v[48:49], v[48:49], 1.0 op_sel_hi:[1,0]
    v_pk_add_f32 v[56:57], v[56:57], 1.0 op_sel_hi:[1,0]
    v_pk_fma_f32 v[32:33], v[32:33], v[50:51], v[32:33]
    v_pk_fma_f32 v[40:41], v[40:41], v[58:59], v[40:41]
    v_pk_fma_f32 v[32:33], v[34:35], v[48:49], v[32:33]
    v_pk_fma_f32 v[40:41], v[42:43], v[56:57], v[40:41]
    v_pk_fma_f32 v[48:49], v[48:49], v[50:51], v[48:49]
    v_pk_fma_f32 v[56:57], v[56:57], v[58:59], v[56:57]
    v_pk_fma_f32 v[32:33], v[32:33], v[52:53], v[32:33]
    v_pk_fma_f32 v[40:41], v[40:41], v[60:61], v[40:41]
    v_pk_fma_f32 v[32:33], v[36:37], v[48:49], v[32:33]
    v_pk_fma_f32 v[40:41], v[44:45], v[56:57], v[40:41]
    v_pk_fma_f32 v[48:49], v[48:49], v[52:53], v[48:49]
    v_pk_fma_f32 v[56:57], v[56:57], v[60:61], v[56:57]
    v_pk_fma_f32 v[32:33], v[32:33], v[54:55], v[32:33]
    v_pk_fma_f32 v[40:41], v[40:41], v[62:63], v[40:41]
    v_pk_fma_f32 v[32:33], v[38:39], v[48:49], v[32:33]
    v_pk_fma_f32 v[40:41], v[46:47], v[56:57], v[40:41]
    v_pk_fma_f32 v[48:49], v[48:49], v[54:55], v[48:49]
    v_pk_fma_f32 v[56:57], v[56:57], v[62:63], v[56:57]
    s_waitcnt lgkmcnt(0)
    v_pk_fma_f32 v[14:15], v[48:49], v[56:57], v[14:15]
    v_rcp_f32 v48, v48
    v_rcp_f32 v49, v49
    v_rcp_f32 v56, v56
    v_rcp_f32 v57, v57
    v_pk_mul_f32 v[32:33], v[32:33], v[48:49]
    v_pk_mul_f32 v[40:41], v[40:41], v[56:57]
    v_cvt_pk_bf16_f32 v134, v32, v33
    v_cvt_pk_bf16_f32 v135, v40, v41
    s_mov_b32 s55, 1
    s_cmp_lg_u32 s26, 2
    s_cbranch_scc1 K2_NX2
LW2:
    ds_read_b32 v164, v167 offset:44
    s_waitcnt lgkmcnt(0)
    v_readfirstlane_b32 s66, v164
    s_nop 0
    s_cmp_ge_u32 s66, 4
    s_cbranch_scc1 LX2
    s_sleep 1
    s_branch LW2
LX2:
K2_NX2:
LW3:
    ds_read_b32 v164, v167 offset:40
    ds_read_b32 v5, v167 offset:16
    s_waitcnt lgkmcnt(0)
    v_readfirstlane_b32 s66, v164
    s_nop 0
    s_cmp_ge_u32 s66, 8
    s_cbranch_scc1 LX3
    s_sleep 1
    s_branch LW3
LX3:
    v_readfirstlane_b32 s66, v5
    s_cmp_eq_u32 s26, 2
    s_cselect_b32 s53, s66, s53
    s_cmp_eq_u32 s53, -1
    s_cbranch_scc1 K2_SLOW
    s_cmp_eq_u32 s26, 2
    s_cselect_b32 s94, 0, 0
    s_sub_u32 s94, s53, s94
    s_sub_u32 s90, s94, 6
    s_max_i32 s90, s90, 2
    s_mov_b32 s91, 0
    s_sub_u32 s93, s53, 2
    s_cmp_ge_u32 s67, 2
    s_waitcnt vmcnt(0)
    s_cbranch_scc1 K2_NF2
    ds_write_b32 v166, v165
K2_NF2:
    ds_read_b64_tr_b16 v[16:17], v2 offset:0
    ds_read_b64_tr_b16 v[18:19], v2 offset:128
    ds_read_b64_tr_b16 v[20:21], v2 offset:256
    ds_read_b64_tr_b16 v[22:23], v2 offset:384
    ds_read_b64_tr_b16 v[24:25], v2 offset:512
    ds_read_b64_tr_b16 v[26:27], v2 offset:640
    ds_read_b64_tr_b16 v[28:29], v2 offset:768
    ds_read_b64_tr_b16 v[30:31], v2 offset:896
    ds_read_b64_tr_b16 v[116:117], v3 offset:0
    ds_read_b64_tr_b16 v[118:119], v3 offset:128
    ds_read_b64_tr_b16 v[120:121], v3 offset:256
    ds_read_b64_tr_b16 v[122:123], v3 offset:384
    ds_read_b64_tr_b16 v[124:125], v3 offset:512
    ds_read_b64_tr_b16 v[126:127], v3 offset:640
    ds_read_b64_tr_b16 v[128:129], v3 offset:768
    ds_read_b64_tr_b16 v[130:131], v3 offset:896
    s_waitcnt lgkmcnt(0)
    buffer_load_dwordx4 v[136:137], s[32:35], s28 idxen offen offset:0 lds
    buffer_load_dwordx4 v[138:139], s[32:35], s29 idxen offen offset:1024 lds
    buffer_load_dwordx4 v[140:141], s[32:35], s30 idxen offen offset:2048 lds
    buffer_load_dwordx4 v[142:143], s[32:35], s31 idxen offen offset:3072 lds
    s_cmp_lt_u32 s67, 2
    s_cbranch_scc1 K2_F3
    s_cmp_lt_u32 s61, s53
    s_cselect_b32 s86, 320000, 0
    s_cselect_b32 m0, s59, 0x28000
    s_add_u32 s61, s61, 4
    buffer_load_dwordx4 v[12:13], s[84:87], 0 idxen offen lds
    s_mov_b32 m0, s57
    s_add_u32 s59, s59, 4096
K2_F3:
K2_WB:
    ds_read_b32 v164, v11 offset:128
    s_waitcnt lgkmcnt(0)
    v_readfirstlane_b32 s66, v164
    s_nop 0
    s_cmp_eq_u32 s66, -1
    s_cbranch_scc1 K2_XB
    s_sleep 1
    s_branch K2_WB
K2_XB:
    ds_read_b128 v[104:107], v1 offset:1024
    s_sub_u32 s68, 1, s25
    s_and_b32 s68, s68, 3
    s_sub_u32 s69, 1, s68
    s_lshl_b32 s67, s69, 7
    s_lshl_b32 s69, s69, 10
    v_add_u32 v7, s69, v7
    v_add_u32 v1, s69, v1
    v_add_u32 v10, s67, v10
    v_add_u32 v11, s67, v11
    s_mov_b64 exec, s[62:63]
    v_add_u32 v8, s69, v8
    s_mov_b64 exec, s[64:65]
    v_add_u32 v9, s69, v9
    s_mov_b64 exec, -1
    s_waitcnt lgkmcnt(0)
    v_mfma_f32_32x32x16_bf16 v[16:31], v[104:107], v[80:83], v[16:31]
    v_mfma_f32_32x32x16_bf16 v[16:31], v[108:111], v[88:91], v[16:31]
    s_nop 8
    s_cmp_eq_u32 s68, 1
    s_cbranch_scc1 K2_U1
    s_cmp_eq_u32 s68, 2
    s_cbranch_scc1 K2_U2
    s_cmp_eq_u32 s68, 3
    s_cbranch_scc1 K2_U3
.p2align 6
K2_U0:
    v_mfma_f32_32x32x16_bf16 v[32:47], v[104:107], v[84:87], v[116:131]
    v_exp_f32 v48, v16
    v_exp_f32 v49, v17
    ds_read_b32 v164, v11 offset:128
    ds_read_b32 v136, v10 offset:256
    ds_read_b32 v138, v10 offset:288
    ds_read_b32 v140, v10 offset:320
    ds_read_b32 v142, v10 offset:352
    ds_read_b32 v12, v11 offset:512
    v_exp_f32 v50, v18
    v_mfma_f32_32x32x16_bf16 v[32:47], v[108:111], v[92:95], v[32:47]
    v_exp_f32 v51, v19
    v_exp_f32 v52, v20
    v_exp_f32 v53, v21
    v_mfma_f32_32x32x16_bf16 v[64:79], v[132:135], v[112:115], v[64:79]
    v_exp_f32 v54, v22
    v_exp_f32 v55, v23
    v_exp_f32 v56, v24
    v_exp_f32 v57, v25
    v_exp_f32 v58, v26
    v_exp_f32 v59, v27
    v_exp_f32 v60, v28
    s_waitcnt lgkmcnt(0)
    v_readfirstlane_b32 s66, v164
    v_exp_f32 v61, v29
    v_exp_f32 v62, v30
    v_exp_f32 v63, v31
    s_cmp_eq_u32 s66, -1
    ds_read_b128 v[108:111], v7 offset:1024
    ds_read_b64_tr_b16 v[112:113], v8 offset:0
    ds_read_b64_tr_b16 v[114:115], v9 offset:0
    s_cbranch_scc0 K2_FW0
K2_FR0:
    ds_read_b128 v[104:107], v1 offset:1024
    v_pk_add_f32 v[48:49], v[48:49], 1.0 op_sel_hi:[1,0]
    v_pk_add_f32 v[56:57], v[56:57], 1.0 op_sel_hi:[1,0]
    v_pk_fma_f32 v[16:17], v[16:17], v[50:51], v[16:17]
    v_pk_fma_f32 v[24:25], v[24:25], v[58:59], v[24:25]
    v_pk_fma_f32 v[16:17], v[18:19], v[48:49], v[16:17]
    v_pk_fma_f32 v[24:25], v[26:27], v[56:57], v[24:25]
    v_pk_fma_f32 v[48:49], v[48:49], v[50:51], v[48:49]
    v_pk_fma_f32 v[56:57], v[56:57], v[58:59], v[56:57]
    v_pk_fma_f32 v[16:17], v[16:17], v[52:53], v[16:17]
    v_pk_fma_f32 v[24:25], v[24:25], v[60:61], v[24:25]
    v_pk_fma_f32 v[16:17], v[20:21], v[48:49], v[16:17]
    v_pk_fma_f32 v[24:25], v[28:29], v[56:57], v[24:25]
    v_pk_fma_f32 v[48:49], v[48:49], v[52:53], v[48:49]
    v_pk_fma_f32 v[56:57], v[56:57], v[60:61], v[56:57]
    v_pk_fma_f32 v[16:17], v[16:17], v[54:55], v[16:17]
    v_pk_fma_f32 v[24:25], v[24:25], v[62:63], v[24:25]
    v_pk_fma_f32 v[16:17], v[22:23], v[48:49], v[16:17]
    v_pk_fma_f32 v[24:25], v[30:31], v[56:57], v[24:25]
    v_pk_fma_f32 v[48:49], v[48:49], v[54:55], v[48:49]
    v_pk_fma_f32 v[56:57], v[56:57], v[62:63], v[56:57]
    v_pk_fma_f32 v[14:15], v[48:49], v[56:57], v[14:15]
    v_rcp_f32 v48, v48
    v_rcp_f32 v49, v49
    v_rcp_f32 v56, v56
    v_rcp_f32 v57, v57
    v_pk_mul_f32 v[16:17], v[16:17], v[48:49]
    v_pk_mul_f32 v[24:25], v[24:25], v[56:57]
    v_cvt_pk_bf16_f32 v132, v16, v17
    v_cvt_pk_bf16_f32 v133, v24, v25
    s_waitcnt vmcnt(0)
    ds_read_b64_tr_b16 v[16:17], v2 offset:0
    ds_read_b64_tr_b16 v[18:19], v2 offset:128
    ds_read_b64_tr_b16 v[20:21], v2 offset:256
    ds_read_b64_tr_b16 v[22:23], v2 offset:384
    ds_read_b64_tr_b16 v[24:25], v2 offset:512
    ds_read_b64_tr_b16 v[26:27], v2 offset:640
    ds_read_b64_tr_b16 v[28:29], v2 offset:768
    ds_read_b64_tr_b16 v[30:31], v2 offset:896
    v_exp_f32 v48, v32
    ds_read_b64_tr_b16 v[116:117], v3 offset:0
    ds_read_b64_tr_b16 v[118:119], v3 offset:128
    ds_read_b64_tr_b16 v[120:121], v3 offset:256
    ds_read_b64_tr_b16 v[122:123], v3 offset:384
    v_exp_f32 v49, v33
    ds_read_b64_tr_b16 v[124:125], v3 offset:512
    ds_read_b64_tr_b16 v[126:127], v3 offset:640
    ds_read_b64_tr_b16 v[128:129], v3 offset:768
    ds_read_b64_tr_b16 v[130:131], v3 offset:896
    v_exp_f32 v50, v34
    v_exp_f32 v51, v35
    v_exp_f32 v52, v36
    v_exp_f32 v53, v37
    v_exp_f32 v54, v38
    s_cmp_ge_i32 s55, s93
    s_waitcnt lgkmcnt(0)
    s_cbranch_scc1 K2_ND0
    buffer_load_dwordx4 v[136:137], s[32:35], s28 idxen offen offset:0 lds
    buffer_load_dwordx4 v[138:139], s[32:35], s29 idxen offen offset:1024 lds
    buffer_load_dwordx4 v[140:141], s[32:35], s30 idxen offen offset:2048 lds
    buffer_load_dwordx4 v[142:143], s[32:35], s31 idxen offen offset:3072 lds
K2_ND0:
    s_cmp_lt_u32 s61, s53
    s_cselect_b32 s86, 320000, 0
    s_cselect_b32 m0, s59, 0x28000
    s_add_u32 s61, s61, 4
    buffer_load_dwordx4 v[12:13], s[84:87], 0 idxen offen lds
    s_mov_b32 m0, s57
    s_add_u32 s59, s59, 4096
    v_exp_f32 v55, v39
    v_mfma_f32_32x32x16_bf16 v[16:31], v[104:107], v[80:83], v[16:31]
    v_exp_f32 v56, v40
    v_exp_f32 v57, v41
    v_exp_f32 v58, v42
    v_mfma_f32_32x32x16_bf16 v[16:31], v[108:111], v[88:91], v[16:31]
    v_exp_f32 v59, v43
    v_exp_f32 v60, v44
    v_exp_f32 v61, v45
    v_exp_f32 v62, v46
    v_exp_f32 v63, v47
    v_pk_add_f32 v[48:49], v[48:49], 1.0 op_sel_hi:[1,0]
    v_pk_add_f32 v[56:57], v[56:57], 1.0 op_sel_hi:[1,0]
    v_pk_fma_f32 v[32:33], v[32:33], v[50:51], v[32:33]
    v_pk_fma_f32 v[40:41], v[40:41], v[58:59], v[40:41]
    v_pk_fma_f32 v[32:33], v[34:35], v[48:49], v[32:33]
    v_pk_fma_f32 v[40:41], v[42:43], v[56:57], v[40:41]
    v_pk_fma_f32 v[48:49], v[48:49], v[50:51], v[48:49]
    v_pk_fma_f32 v[56:57], v[56:57], v[58:59], v[56:57]
    v_pk_fma_f32 v[32:33], v[32:33], v[52:53], v[32:33]
    v_pk_fma_f32 v[40:41], v[40:41], v[60:61], v[40:41]
    v_pk_fma_f32 v[32:33], v[36:37], v[48:49], v[32:33]
    v_pk_fma_f32 v[40:41], v[44:45], v[56:57], v[40:41]
    v_pk_fma_f32 v[48:49], v[48:49], v[52:53], v[48:49]
    v_pk_fma_f32 v[56:57], v[56:57], v[60:61], v[56:57]
    v_pk_fma_f32 v[32:33], v[32:33], v[54:55], v[32:33]
    v_pk_fma_f32 v[40:41], v[40:41], v[62:63], v[40:41]
    v_pk_fma_f32 v[32:33], v[38:39], v[48:49], v[32:33]
    v_pk_fma_f32 v[40:41], v[46:47], v[56:57], v[40:41]
    v_pk_fma_f32 v[48:49], v[48:49], v[54:55], v[48:49]
    v_pk_fma_f32 v[56:57], v[56:57], v[62:63], v[56:57]
    v_pk_fma_f32 v[14:15], v[48:49], v[56:57], v[14:15]
    v_rcp_f32 v48, v48
    v_rcp_f32 v49, v49
    v_rcp_f32 v56, v56
    v_rcp_f32 v57, v57
    v_pk_mul_f32 v[32:33], v[32:33], v[48:49]
    v_pk_mul_f32 v[40:41], v[40:41], v[56:57]
    v_cvt_pk_bf16_f32 v134, v32, v33
    v_cvt_pk_bf16_f32 v135, v40, v41
    s_add_u32 s55, s55, 1
    s_cmp_ge_u32 s55, s90
    s_cbranch_scc1 K2_TH0
K2_U1:
    v_mfma_f32_32x32x16_bf16 v[32:47], v[104:107], v[84:87], v[116:131]
    v_exp_f32 v48, v16
    v_exp_f32 v49, v17
    ds_read_b32 v164, v11 offset:256
    ds_read_b32 v136, v10 offset:384
    ds_read_b32 v138, v10 offset:416
    ds_read_b32 v140, v10 offset:448
    ds_read_b32 v142, v10 offset:480
    v_exp_f32 v50, v18
    v_mfma_f32_32x32x16_bf16 v[32:47], v[108:111], v[92:95], v[32:47]
    v_exp_f32 v51, v19
    v_exp_f32 v52, v20
    v_exp_f32 v53, v21
    v_mfma_f32_32x32x16_bf16 v[64:79], v[132:135], v[112:115], v[64:79]
    v_exp_f32 v54, v22
    v_exp_f32 v55, v23
    v_exp_f32 v56, v24
    v_exp_f32 v57, v25
    v_exp_f32 v58, v26
    v_exp_f32 v59, v27
    v_exp_f32 v60, v28
    s_waitcnt lgkmcnt(0)
    v_readfirstlane_b32 s66, v164
    v_exp_f32 v61, v29
    v_exp_f32 v62, v30
    v_exp_f32 v63, v31
    s_cmp_eq_u32 s66, -1
    ds_read_b128 v[108:111], v7 offset:2048
    ds_read_b64_tr_b16 v[112:113], v8 offset:1024
    ds_read_b64_tr_b16 v[114:115], v9 offset:1024
    s_cbranch_scc0 K2_FW1
K2_FR1:
    ds_read_b128 v[104:107], v1 offset:2048
    v_pk_add_f32 v[48:49], v[48:49], 1.0 op_sel_hi:[1,0]
    v_pk_add_f32 v[56:57], v[56:57], 1.0 op_sel_hi:[1,0]
    v_pk_fma_f32 v[16:17], v[16:17], v[50:51], v[16:17]
    v_pk_fma_f32 v[24:25], v[24:25], v[58:59], v[24:25]
    v_pk_fma_f32 v[16:17], v[18:19], v[48:49], v[16:17]
    v_pk_fma_f32 v[24:25], v[26:27], v[56:57], v[24:25]
    v_pk_fma_f32 v[48:49], v[48:49], v[50:51], v[48:49]
    v_pk_fma_f32 v[56:57], v[56:57], v[58:59], v[56:57]
    v_pk_fma_f32 v[16:17], v[16:17], v[52:53], v[16:17]
    v_pk_fma_f32 v[24:25], v[24:25], v[60:61], v[24:25]
    v_pk_fma_f32 v[16:17], v[20:21], v[48:49], v[16:17]
    v_pk_fma_f32 v[24:25], v[28:29], v[56:57], v[24:25]
    v_pk_fma_f32 v[48:49], v[48:49], v[52:53], v[48:49]
    v_pk_fma_f32 v[56:57], v[56:57], v[60:61], v[56:57]
    v_pk_fma_f32 v[16:17], v[16:17], v[54:55], v[16:17]
    v_pk_fma_f32 v[24:25], v[24:25], v[62:63], v[24:25]
    v_pk_fma_f32 v[16:17], v[22:23], v[48:49], v[16:17]
    v_pk_fma_f32 v[24:25], v[30:31], v[56:57], v[24:25]
    v_pk_fma_f32 v[48:49], v[48:49], v[54:55], v[48:49]
    v_pk_fma_f32 v[56:57], v[56:57], v[62:63], v[56:57]
    v_pk_fma_f32 v[14:15], v[48:49], v[56:57], v[14:15]
    v_rcp_f32 v48, v48
    v_rcp_f32 v49, v49
    v_rcp_f32 v56, v56
    v_rcp_f32 v57, v57
    v_pk_mul_f32 v[16:17], v[16:17], v[48:49]
    v_pk_mul_f32 v[24:25], v[24:25], v[56:57]
    v_cvt_pk_bf16_f32 v132, v16, v17
    v_cvt_pk_bf16_f32 v133, v24, v25
    s_waitcnt vmcnt(1)
    ds_read_b64_tr_b16 v[16:17], v2 offset:0
    ds_read_b64_tr_b16 v[18:19], v2 offset:128
    ds_read_b64_tr_b16 v[20:21], v2 offset:256
    ds_read_b64_tr_b16 v[22:23], v2 offset:384
    ds_read_b64_tr_b16 v[24:25], v2 offset:512
    ds_read_b64_tr_b16 v[26:27], v2 offset:640
    ds_read_b64_tr_b16 v[28:29], v2 offset:768
    ds_read_b64_tr_b16 v[30:31], v2 offset:896
    v_exp_f32 v48, v32
    ds_read_b64_tr_b16 v[116:117], v3 offset:0
    ds_read_b64_tr_b16 v[118:119], v3 offset:128
    ds_read_b64_tr_b16 v[120:121], v3 offset:256
    ds_read_b64_tr_b16 v[122:123], v3 offset:384
    v_exp_f32 v49, v33
    ds_read_b64_tr_b16 v[124:125], v3 offset:512
    ds_read_b64_tr_b16 v[126:127], v3 offset:640
    ds_read_b64_tr_b16 v[128:129], v3 offset:768
    ds_read_b64_tr_b16 v[130:131], v3 offset:896
    v_exp_f32 v50, v34
    v_exp_f32 v51, v35
    v_exp_f32 v52, v36
    v_exp_f32 v53, v37
    v_exp_f32 v54, v38
    s_cmp_ge_i32 s55, s93
    s_waitcnt lgkmcnt(0)
    s_cbranch_scc1 K2_ND1
    buffer_load_dwordx4 v[136:137], s[32:35], s28 idxen offen offset:0 lds
    buffer_load_dwordx4 v[138:139], s[32:35], s29 idxen offen offset:1024 lds
    buffer_load_dwordx4 v[140:141], s[32:35], s30 idxen offen offset:2048 lds
    buffer_load_dwordx4 v[142:143], s[32:35], s31 idxen offen offset:3072 lds
K2_ND1:
    v_exp_f32 v55, v39
    v_mfma_f32_32x32x16_bf16 v[16:31], v[104:107], v[80:83], v[16:31]
    v_exp_f32 v56, v40
    v_exp_f32 v57, v41
    v_exp_f32 v58, v42
    v_mfma_f32_32x32x16_bf16 v[16:31], v[108:111], v[88:91], v[16:31]
    v_exp_f32 v59, v43
    v_exp_f32 v60, v44
    v_exp_f32 v61, v45
    v_exp_f32 v62, v46
    v_exp_f32 v63, v47
    v_pk_add_f32 v[48:49], v[48:49], 1.0 op_sel_hi:[1,0]
    v_pk_add_f32 v[56:57], v[56:57], 1.0 op_sel_hi:[1,0]
    v_pk_fma_f32 v[32:33], v[32:33], v[50:51], v[32:33]
    v_pk_fma_f32 v[40:41], v[40:41], v[58:59], v[40:41]
    v_pk_fma_f32 v[32:33], v[34:35], v[48:49], v[32:33]
    v_pk_fma_f32 v[40:41], v[42:43], v[56:57], v[40:41]
    v_pk_fma_f32 v[48:49], v[48:49], v[50:51], v[48:49]
    v_pk_fma_f32 v[56:57], v[56:57], v[58:59], v[56:57]
    v_pk_fma_f32 v[32:33], v[32:33], v[52:53], v[32:33]
    v_pk_fma_f32 v[40:41], v[40:41], v[60:61], v[40:41]
    v_pk_fma_f32 v[32:33], v[36:37], v[48:49], v[32:33]
    v_pk_fma_f32 v[40:41], v[44:45], v[56:57], v[40:41]
    v_pk_fma_f32 v[48:49], v[48:49], v[52:53], v[48:49]
    v_pk_fma_f32 v[56:57], v[56:57], v[60:61], v[56:57]
    v_pk_fma_f32 v[32:33], v[32:33], v[54:55], v[32:33]
    v_pk_fma_f32 v[40:41], v[40:41], v[62:63], v[40:41]
    v_pk_fma_f32 v[32:33], v[38:39], v[48:49], v[32:33]
    v_pk_fma_f32 v[40:41], v[46:47], v[56:57], v[40:41]
    v_pk_fma_f32 v[48:49], v[48:49], v[54:55], v[48:49]
    v_pk_fma_f32 v[56:57], v[56:57], v[62:63], v[56:57]
    v_pk_fma_f32 v[14:15], v[48:49], v[56:57], v[14:15]
    v_rcp_f32 v48, v48
    v_rcp_f32 v49, v49
    v_rcp_f32 v56, v56
    v_rcp_f32 v57, v57
    v_pk_mul_f32 v[32:33], v[32:33], v[48:49]
    v_pk_mul_f32 v[40:41], v[40:41], v[56:57]
    v_cvt_pk_bf16_f32 v134, v32, v33
    v_cvt_pk_bf16_f32 v135, v40, v41
    s_add_u32 s55, s55, 1
    s_cmp_ge_u32 s55, s90
    s_cbranch_scc1 K2_TH1
K2_U2:
    v_mfma_f32_32x32x16_bf16 v[32:47], v[104:107], v[84:87], v[116:131]
    v_exp_f32 v48, v16
    v_exp_f32 v49, v17
    ds_read_b32 v164, v11 offset:384
    ds_read_b32 v136, v10 offset:512
    ds_read_b32 v138, v10 offset:544
    ds_read_b32 v140, v10 offset:576
    ds_read_b32 v142, v10 offset:608
    v_exp_f32 v50, v18
    v_mfma_f32_32x32x16_bf16 v[32:47], v[108:111], v[92:95], v[32:47]
    v_exp_f32 v51, v19
    v_exp_f32 v52, v20
    v_exp_f32 v53, v21
    v_mfma_f32_32x32x16_bf16 v[64:79], v[132:135], v[112:115], v[64:79]
    v_exp_f32 v54, v22
    v_exp_f32 v55, v23
    v_exp_f32 v56, v24
    v_exp_f32 v57, v25
    v_exp_f32 v58, v26
    v_exp_f32 v59, v27
    v_exp_f32 v60, v28
    s_waitcnt lgkmcnt(0)
    v_readfirstlane_b32 s66, v164
    v_exp_f32 v61, v29
    v_exp_f32 v62, v30
    v_exp_f32 v63, v31
    s_cmp_eq_u32 s66, -1
    ds_read_b128 v[108:111], v7 offset:3072
    ds_read_b64_tr_b16 v[112:113], v8 offset:2048
    ds_read_b64_tr_b16 v[114:115], v9 offset:2048
    s_cbranch_scc0 K2_FW2
K2_FR2:
    ds_read_b128 v[104:107], v1 offset:3072
    v_pk_add_f32 v[48:49], v[48:49], 1.0 op_sel_hi:[1,0]
    v_pk_add_f32 v[56:57], v[56:57], 1.0 op_sel_hi:[1,0]
    v_pk_fma_f32 v[16:17], v[16:17], v[50:51], v[16:17]
    v_pk_fma_f32 v[24:25], v[24:25], v[58:59], v[24:25]
    v_pk_fma_f32 v[16:17], v[18:19], v[48:49], v[16:17]
    v_pk_fma_f32 v[24:25], v[26:27], v[56:57], v[24:25]
    v_pk_fma_f32 v[48:49], v[48:49], v[50:51], v[48:49]
    v_pk_fma_f32 v[56:57], v[56:57], v[58:59], v[56:57]
    v_pk_fma_f32 v[16:17], v[16:17], v[52:53], v[16:17]
    v_pk_fma_f32 v[24:25], v[24:25], v[60:61], v[24:25]
    v_pk_fma_f32 v[16:17], v[20:21], v[48:49], v[16:17]
    v_pk_fma_f32 v[24:25], v[28:29], v[56:57], v[24:25]
    v_pk_fma_f32 v[48:49], v[48:49], v[52:53], v[48:49]
    v_pk_fma_f32 v[56:57], v[56:57], v[60:61], v[56:57]
    v_pk_fma_f32 v[16:17], v[16:17], v[54:55], v[16:17]
    v_pk_fma_f32 v[24:25], v[24:25], v[62:63], v[24:25]
    v_pk_fma_f32 v[16:17], v[22:23], v[48:49], v[16:17]
    v_pk_fma_f32 v[24:25], v[30:31], v[56:57], v[24:25]
    v_pk_fma_f32 v[48:49], v[48:49], v[54:55], v[48:49]
    v_pk_fma_f32 v[56:57], v[56:57], v[62:63], v[56:57]
    v_pk_fma_f32 v[14:15], v[48:49], v[56:57], v[14:15]
    v_rcp_f32 v48, v48
    v_rcp_f32 v49, v49
    v_rcp_f32 v56, v56
    v_rcp_f32 v57, v57
    v_pk_mul_f32 v[16:17], v[16:17], v[48:49]
    v_pk_mul_f32 v[24:25], v[24:25], v[56:57]
    v_cvt_pk_bf16_f32 v132, v16, v17
    v_cvt_pk_bf16_f32 v133, v24, v25
    s_waitcnt vmcnt(0)
    ds_read_b64_tr_b16 v[16:17], v2 offset:0
    ds_read_b64_tr_b16 v[18:19], v2 offset:128
    ds_read_b64_tr_b16 v[20:21], v2 offset:256
    ds_read_b64_tr_b16 v[22:23], v2 offset:384
    ds_read_b64_tr_b16 v[24:25], v2 offset:512
    ds_read_b64_tr_b16 v[26:27], v2 offset:640
    ds_read_b64_tr_b16 v[28:29], v2 offset:768
    ds_read_b64_tr_b16 v[30:31], v2 offset:896
    v_exp_f32 v48, v32
    ds_read_b64_tr_b16 v[116:117], v3 offset:0
    ds_read_b64_tr_b16 v[118:119], v3 offset:128
    ds_read_b64_tr_b16 v[120:121], v3 offset:256
    ds_read_b64_tr_b16 v[122:123], v3 offset:384
    v_exp_f32 v49, v33
    ds_read_b64_tr_b16 v[124:125], v3 offset:512
    ds_read_b64_tr_b16 v[126:127], v3 offset:640
    ds_read_b64_tr_b16 v[128:129], v3 offset:768
    ds_read_b64_tr_b16 v[130:131], v3 offset:896
    v_exp_f32 v50, v34
    v_exp_f32 v51, v35
    v_exp_f32 v52, v36
    v_exp_f32 v53, v37
    v_exp_f32 v54, v38
    s_cmp_ge_i32 s55, s93
    s_waitcnt lgkmcnt(0)
    s_cbranch_scc1 K2_ND2
    ds_write_b32 v11, v165 offset:512
    buffer_load_dwordx4 v[136:137], s[32:35], s28 idxen offen offset:0 lds
    buffer_load_dwordx4 v[138:139], s[32:35], s29 idxen offen offset:1024 lds
    buffer_load_dwordx4 v[140:141], s[32:35], s30 idxen offen offset:2048 lds
    buffer_load_dwordx4 v[142:143], s[32:35], s31 idxen offen offset:3072 lds
K2_ND2:
    v_exp_f32 v55, v39
    v_mfma_f32_32x32x16_bf16 v[16:31], v[104:107], v[80:83], v[16:31]
    v_exp_f32 v56, v40
    v_exp_f32 v57, v41
    v_exp_f32 v58, v42
    v_mfma_f32_32x32x16_bf16 v[16:31], v[108:111], v[88:91], v[16:31]
    v_exp_f32 v59, v43
    v_exp_f32 v60, v44
    v_exp_f32 v61, v45
    v_exp_f32 v62, v46
    v_exp_f32 v63, v47
    v_pk_add_f32 v[48:49], v[48:49], 1.0 op_sel_hi:[1,0]
    v_pk_add_f32 v[56:57], v[56:57], 1.0 op_sel_hi:[1,0]
    v_pk_fma_f32 v[32:33], v[32:33], v[50:51], v[32:33]
    v_pk_fma_f32 v[40:41], v[40:41], v[58:59], v[40:41]
    v_pk_fma_f32 v[32:33], v[34:35], v[48:49], v[32:33]
    v_pk_fma_f32 v[40:41], v[42:43], v[56:57], v[40:41]
    v_pk_fma_f32 v[48:49], v[48:49], v[50:51], v[48:49]
    v_pk_fma_f32 v[56:57], v[56:57], v[58:59], v[56:57]
    v_pk_fma_f32 v[32:33], v[32:33], v[52:53], v[32:33]
    v_pk_fma_f32 v[40:41], v[40:41], v[60:61], v[40:41]
    v_pk_fma_f32 v[32:33], v[36:37], v[48:49], v[32:33]
    v_pk_fma_f32 v[40:41], v[44:45], v[56:57], v[40:41]
    v_pk_fma_f32 v[48:49], v[48:49], v[52:53], v[48:49]
    v_pk_fma_f32 v[56:57], v[56:57], v[60:61], v[56:57]
    v_pk_fma_f32 v[32:33], v[32:33], v[54:55], v[32:33]
    v_pk_fma_f32 v[40:41], v[40:41], v[62:63], v[40:41]
    v_pk_fma_f32 v[32:33], v[38:39], v[48:49], v[32:33]
    v_pk_fma_f32 v[40:41], v[46:47], v[56:57], v[40:41]
    v_pk_fma_f32 v[48:49], v[48:49], v[54:55], v[48:49]
    v_pk_fma_f32 v[56:57], v[56:57], v[62:63], v[56:57]
    v_pk_fma_f32 v[14:15], v[48:49], v[56:57], v[14:15]
    v_rcp_f32 v48, v48
    v_rcp_f32 v49, v49
    v_rcp_f32 v56, v56
    v_rcp_f32 v57, v57
    v_pk_mul_f32 v[32:33], v[32:33], v[48:49]
    v_pk_mul_f32 v[40:41], v[40:41], v[56:57]
    v_cvt_pk_bf16_f32 v134, v32, v33
    v_cvt_pk_bf16_f32 v135, v40, v41
    s_add_u32 s55, s55, 1
    s_cmp_ge_u32 s55, s90
    s_cbranch_scc1 K2_TH2
K2_U3:
    v_mfma_f32_32x32x16_bf16 v[32:47], v[104:107], v[84:87], v[116:131]
    v_exp_f32 v48, v16
    v_exp_f32 v49, v17
    ds_read_b32 v164, v11 offset:512
    ds_read_b32 v136, v10 offset:640
    ds_read_b32 v138, v10 offset:672
    ds_read_b32 v140, v10 offset:704
    ds_read_b32 v142, v10 offset:736
    v_exp_f32 v50, v18
    v_mfma_f32_32x32x16_bf16 v[32:47], v[108:111], v[92:95], v[32:47]
    v_exp_f32 v51, v19
    v_exp_f32 v52, v20
    v_exp_f32 v53, v21
    v_mfma_f32_32x32x16_bf16 v[64:79], v[132:135], v[112:115], v[64:79]
    v_exp_f32 v54, v22
    v_exp_f32 v55, v23
    v_exp_f32 v56, v24
    v_exp_f32 v57, v25
    v_exp_f32 v58, v26
    v_exp_f32 v59, v27
    v_exp_f32 v60, v28
    s_waitcnt lgkmcnt(0)
    v_readfirstlane_b32 s66, v164
    v_exp_f32 v61, v29
    v_exp_f32 v62, v30
    v_exp_f32 v63, v31
    s_cmp_eq_u32 s66, -1
    ds_read_b128 v[108:111], v7 offset:4096
    ds_read_b64_tr_b16 v[112:113], v8 offset:3072
    ds_read_b64_tr_b16 v[114:115], v9 offset:3072
    s_cbranch_scc0 K2_FW3
K2_FR3:
    ds_read_b128 v[104:107], v1 offset:4096
    v_pk_add_f32 v[48:49], v[48:49], 1.0 op_sel_hi:[1,0]
    v_pk_add_f32 v[56:57], v[56:57], 1.0 op_sel_hi:[1,0]
    v_pk_fma_f32 v[16:17], v[16:17], v[50:51], v[16:17]
    v_pk_fma_f32 v[24:25], v[24:25], v[58:59], v[24:25]
    v_pk_fma_f32 v[16:17], v[18:19], v[48:49], v[16:17]
    v_pk_fma_f32 v[24:25], v[26:27], v[56:57], v[24:25]
    v_pk_fma_f32 v[48:49], v[48:49], v[50:51], v[48:49]
    v_pk_fma_f32 v[56:57], v[56:57], v[58:59], v[56:57]
    v_pk_fma_f32 v[16:17], v[16:17], v[52:53], v[16:17]
    v_pk_fma_f32 v[24:25], v[24:25], v[60:61], v[24:25]
    v_pk_fma_f32 v[16:17], v[20:21], v[48:49], v[16:17]
    v_pk_fma_f32 v[24:25], v[28:29], v[56:57], v[24:25]
    v_pk_fma_f32 v[48:49], v[48:49], v[52:53], v[48:49]
    v_pk_fma_f32 v[56:57], v[56:57], v[60:61], v[56:57]
    v_pk_fma_f32 v[16:17], v[16:17], v[54:55], v[16:17]
    v_pk_fma_f32 v[24:25], v[24:25], v[62:63], v[24:25]
    v_pk_fma_f32 v[16:17], v[22:23], v[48:49], v[16:17]
    v_pk_fma_f32 v[24:25], v[30:31], v[56:57], v[24:25]
    v_pk_fma_f32 v[48:49], v[48:49], v[54:55], v[48:49]
    v_pk_fma_f32 v[56:57], v[56:57], v[62:63], v[56:57]
    v_pk_fma_f32 v[14:15], v[48:49], v[56:57], v[14:15]
    v_rcp_f32 v48, v48
    v_rcp_f32 v49, v49
    v_rcp_f32 v56, v56
    v_rcp_f32 v57, v57
    v_pk_mul_f32 v[16:17], v[16:17], v[48:49]
    v_pk_mul_f32 v[24:25], v[24:25], v[56:57]
    v_cvt_pk_bf16_f32 v132, v16, v17
    v_cvt_pk_bf16_f32 v133, v24, v25
    s_waitcnt vmcnt(0)
    ds_read_b64_tr_b16 v[16:17], v2 offset:0
    ds_read_b64_tr_b16 v[18:19], v2 offset:128
    ds_read_b64_tr_b16 v[20:21], v2 offset:256
    ds_read_b64_tr_b16 v[22:23], v2 offset:384
    ds_read_b64_tr_b16 v[24:25], v2 offset:512
    ds_read_b64_tr_b16 v[26:27], v2 offset:640
    ds_read_b64_tr_b16 v[28:29], v2 offset:768
    ds_read_b64_tr_b16 v[30:31], v2 offset:896
    v_exp_f32 v48, v32
    ds_read_b64_tr_b16 v[116:117], v3 offset:0
    ds_read_b64_tr_b16 v[118:119], v3 offset:128
    ds_read_b64_tr_b16 v[120:121], v3 offset:256
    ds_read_b64_tr_b16 v[122:123], v3 offset:384
    v_exp_f32 v49, v33
    ds_read_b64_tr_b16 v[124:125], v3 offset:512
    ds_read_b64_tr_b16 v[126:127], v3 offset:640
    ds_read_b64_tr_b16 v[128:129], v3 offset:768
    ds_read_b64_tr_b16 v[130:131], v3 offset:896
    v_exp_f32 v50, v34
    v_exp_f32 v51, v35
    v_exp_f32 v52, v36
    v_exp_f32 v53, v37
    v_exp_f32 v54, v38
    s_cmp_ge_i32 s55, s93
    s_waitcnt lgkmcnt(0)
    s_cbranch_scc1 K2_ND3
    buffer_load_dwordx4 v[136:137], s[32:35], s28 idxen offen offset:0 lds
    buffer_load_dwordx4 v[138:139], s[32:35], s29 idxen offen offset:1024 lds
    buffer_load_dwordx4 v[140:141], s[32:35], s30 idxen offen offset:2048 lds
    buffer_load_dwordx4 v[142:143], s[32:35], s31 idxen offen offset:3072 lds
K2_ND3:
    v_exp_f32 v55, v39
    v_mfma_f32_32x32x16_bf16 v[16:31], v[104:107], v[80:83], v[16:31]
    v_exp_f32 v56, v40
    v_exp_f32 v57, v41
    v_exp_f32 v58, v42
    v_mfma_f32_32x32x16_bf16 v[16:31], v[108:111], v[88:91], v[16:31]
    v_exp_f32 v59, v43
    v_exp_f32 v60, v44
    v_exp_f32 v61, v45
    v_exp_f32 v62, v46
    v_exp_f32 v63, v47
    v_add_u32 v7, 4096, v7
    v_add_u32 v1, 4096, v1
    v_add_u32 v10, 512, v10
    v_add_u32 v11, 512, v11
    s_mov_b64 exec, s[62:63]
    v_add_u32 v8, 4096, v8
    s_mov_b64 exec, s[64:65]
    v_add_u32 v9, 4096, v9
    s_mov_b64 exec, -1
    v_pk_add_f32 v[48:49], v[48:49], 1.0 op_sel_hi:[1,0]
    v_pk_add_f32 v[56:57], v[56:57], 1.0 op_sel_hi:[1,0]
    v_pk_fma_f32 v[32:33], v[32:33], v[50:51], v[32:33]
    v_pk_fma_f32 v[40:41], v[40:41], v[58:59], v[40:41]
    v_pk_fma_f32 v[32:33], v[34:35], v[48:49], v[32:33]
    v_pk_fma_f32 v[40:41], v[42:43], v[56:57], v[40:41]
    v_pk_fma_f32 v[48:49], v[48:49], v[50:51], v[48:49]
    v_pk_fma_f32 v[56:57], v[56:57], v[58:59], v[56:57]
    v_pk_fma_f32 v[32:33], v[32:33], v[52:53], v[32:33]
    v_pk_fma_f32 v[40:41], v[40:41], v[60:61], v[40:41]
    v_pk_fma_f32 v[32:33], v[36:37], v[48:49], v[32:33]
    v_pk_fma_f32 v[40:41], v[44:45], v[56:57], v[40:41]
    v_pk_fma_f32 v[48:49], v[48:49], v[52:53], v[48:49]
    v_pk_fma_f32 v[56:57], v[56:57], v[60:61], v[56:57]
    v_pk_fma_f32 v[32:33], v[32:33], v[54:55], v[32:33]
    v_pk_fma_f32 v[40:41], v[40:41], v[62:63], v[40:41]
    v_pk_fma_f32 v[32:33], v[38:39], v[48:49], v[32:33]
    v_pk_fma_f32 v[40:41], v[46:47], v[56:57], v[40:41]
    v_pk_fma_f32 v[48:49], v[48:49], v[54:55], v[48:49]
    v_pk_fma_f32 v[56:57], v[56:57], v[62:63], v[56:57]
    v_pk_fma_f32 v[14:15], v[48:49], v[56:57], v[14:15]
    v_rcp_f32 v48, v48
    v_rcp_f32 v49, v49
    v_rcp_f32 v56, v56
    v_rcp_f32 v57, v57
    v_pk_mul_f32 v[32:33], v[32:33], v[48:49]
    v_pk_mul_f32 v[40:41], v[40:41], v[56:57]
    v_cvt_pk_bf16_f32 v134, v32, v33
    v_cvt_pk_bf16_f32 v135, v40, v41
    s_add_u32 s55, s55, 1
    s_cmp_ge_u32 s55, s90
    s_cbranch_scc1 K2_TH3
    s_branch K2_U0
K2_TH0:
    s_mov_b32 s92, 1
    s_branch K2_TH
K2_TH1:
    s_mov_b32 s92, 2
    s_branch K2_TH
K2_TH2:
    s_mov_b32 s92, 3
    s_branch K2_TH
K2_TH3:
    s_mov_b32 s92, 0
K2_TH:
    s_cmp_ge_u32 s55, s53
    s_cbranch_scc1 K2_EXIT
    s_add_u32 s91, s91, 1
    s_cmp_eq_u32 s91, 1
    s_cbranch_scc0 K2_TH_2
    s_setprio 2
    s_sub_u32 s90, s94, 3
    s_branch K2_TH_R
K2_TH_2:
    s_cmp_eq_u32 s91, 2
    s_cbranch_scc0 K2_TH_3
    s_setprio 1
    s_sub_u32 s90, s94, 1
    s_branch K2_TH_R
K2_TH_3:
    s_setprio 0
    s_mov_b32 s90, s53
K2_TH_R:
    s_max_i32 s90, s90, 0
    s_cmp_eq_u32 s92, 1
    s_cbranch_scc1 K2_U1
    s_cmp_lt_u32 s91, 2
    s_cbranch_scc1 K2_TH_J
    s_cmp_lg_u32 s60, 0
    s_cbranch_scc1 K2_TH_J
    s_mov_b32 s60, 1
    buffer_load_dwordx4 v[144:147], v6, s[40:43], s73 offen offset:0
    buffer_load_dwordx4 v[148:151], v6, s[40:43], s73 offen offset:1024
    buffer_load_dwordx4 v[152:155], v6, s[40:43], s73 offen offset:2048
    buffer_load_dwordx4 v[156:159], v6, s[40:43], s73 offen offset:3072
    buffer_load_dwordx4 v[160:163], v6, s[40:43], s74 offen offset:0
    buffer_load_dwordx4 v[96:99], v6, s[40:43], s74 offen offset:1024
    buffer_load_dwordx4 v[100:103], v6, s[40:43], s74 offen offset:2048
K2_TH_J:
    s_cmp_eq_u32 s92, 2
    s_cbranch_scc1 K2_U2
    s_cmp_eq_u32 s92, 3
    s_cbranch_scc1 K2_U3
    s_branch K2_U0
K2_FW0:
    s_add_u32 s66, s55, 1
    s_cmp_ge_u32 s66, s53
    s_cbranch_scc1 K2_FR0
    ds_read_b32 v164, v11 offset:128
    s_waitcnt lgkmcnt(0)
    v_readfirstlane_b32 s66, v164
    s_nop 0
    s_cmp_eq_u32 s66, -1
    s_cbranch_scc1 K2_FR0
    s_sleep 1
    s_branch K2_FW0
K2_FW1:
    s_add_u32 s66, s55, 1
    s_cmp_ge_u32 s66, s53
    s_cbranch_scc1 K2_FR1
    ds_read_b32 v164, v11 offset:256
    s_waitcnt lgkmcnt(0)
    v_readfirstlane_b32 s66, v164
    s_nop 0
    s_cmp_eq_u32 s66, -1
    s_cbranch_scc1 K2_FR1
    s_sleep 1
    s_branch K2_FW1
K2_FW2:
    s_add_u32 s66, s55, 1
    s_cmp_ge_u32 s66, s53
    s_cbranch_scc1 K2_FR2
    ds_read_b32 v164, v11 offset:384
    s_waitcnt lgkmcnt(0)
    v_readfirstlane_b32 s66, v164
    s_nop 0
    s_cmp_eq_u32 s66, -1
    s_cbranch_scc1 K2_FR2
    s_sleep 1
    s_branch K2_FW2
K2_FW3:
    s_add_u32 s66, s55, 1
    s_cmp_ge_u32 s66, s53
    s_cbranch_scc1 K2_FR3
    ds_read_b32 v164, v11 offset:512
    s_waitcnt lgkmcnt(0)
    v_readfirstlane_b32 s66, v164
    s_nop 0
    s_cmp_eq_u32 s66, -1
    s_cbranch_scc1 K2_FR3
    s_sleep 1
    s_branch K2_FW3
K2_EXIT:
    v_mfma_f32_32x32x16_bf16 v[64:79], v[132:135], v[112:115], v[64:79]
    v_lshrrev_b32 v1, 4, v6
    s_cmp_lg_u32 s60, 0
    s_cbranch_scc1 K2_X1
    buffer_load_dwordx4 v[144:147], v6, s[40:43], s73 offen offset:0
    buffer_load_dwordx4 v[148:151], v6, s[40:43], s73 offen offset:1024
    buffer_load_dwordx4 v[152:155], v6, s[40:43], s73 offen offset:2048
    buffer_load_dwordx4 v[156:159], v6, s[40:43], s73 offen offset:3072
    buffer_load_dwordx4 v[160:163], v6, s[40:43], s74 offen offset:0
    buffer_load_dwordx4 v[96:99], v6, s[40:43], s74 offen offset:1024
    buffer_load_dwordx4 v[100:103], v6, s[40:43], s74 offen offset:2048
K2_X1:
    s_mov_b32 s48, s18
    s_mov_b32 s49, s19
    s_mov_b32 s50, 256
    s_mov_b32 s51, 0x00020000
    buffer_load_dwordx4 v[116:119], v6, s[40:43], s74 offen offset:3072
    v_lshrrev_b32 v8, 4, v1
    v_lshlrev_b32 v9, 3, v8
    s_lshl_b32 s68, s24, 5
    buffer_load_dwordx2 v[10:11], v9, s[48:51], s68 offen
    v_subrev_u32 v2, s71, v1
    v_and_b32 v2, 15, v2
    v_mul_u32_u24 v2, 160, v2
    v_and_b32 v3, 16, v1
    v_lshl_add_u32 v2, v3, 2, v2
    v_lshrrev_b32 v3, 5, v1
    v_lshl_add_u32 v3, v3, 3, s57
    v_add_u32 v2, v2, v3
    s_waitcnt vmcnt(2)
    v_cvt_pk_bf16_f32 v48, v64, v65
    v_cvt_pk_bf16_f32 v49, v66, v67
    ds_write_b64 v2, v[48:49] offset:0
    v_cvt_pk_bf16_f32 v50, v68, v69
    v_cvt_pk_bf16_f32 v51, v70, v71
    ds_write_b64 v2, v[50:51] offset:16
    v_cvt_pk_bf16_f32 v52, v72, v73
    v_cvt_pk_bf16_f32 v53, v74, v75
    ds_write_b64 v2, v[52:53] offset:32
    v_cvt_pk_bf16_f32 v54, v76, v77
    v_cvt_pk_bf16_f32 v55, v78, v79
    ds_write_b64 v2, v[54:55] offset:48
    v_pk_add_f32 v[64:65], v[64:65], v[66:67]
    v_pk_add_f32 v[68:69], v[68:69], v[70:71]
    v_pk_add_f32 v[72:73], v[72:73], v[74:75]
    v_pk_add_f32 v[76:77], v[76:77], v[78:79]
    v_pk_add_f32 v[64:65], v[64:65], v[68:69]
    v_pk_add_f32 v[72:73], v[72:73], v[76:77]
    v_add_f32 v14, v14, v15
    v_pk_add_f32 v[64:65], v[64:65], v[72:73]
    v_mul_f32 v14, 0x41800000, v14
    v_add_f32 v15, v64, v65
    v_mul_f32 v15, 0, v15
    v_mov_b32 v4, 0x207
    v_add_f32 v14, v14, v15
    v_mov_b32 v5, 148736
    v_mov_b32 v7, 1
    v_cmpx_class_f32 vcc, v14, v4
    ds_write_b32 v5, v7
    s_mov_b64 exec, -1
K2_FIN:
    s_cmp_ge_u32 s24, 8
    s_cbranch_scc1 K2_HEND
    s_mov_b64 exec, 1
    ds_add_u32 v5, v7 offset:24
    s_mov_b64 exec, -1
    v_and_b32 v12, 15, v1
    v_mul_u32_u24 v2, 160, v12
    v_lshl_add_u32 v2, v8, 4, v2
    s_mov_b32 s78, 148992
    v_lshl_add_u32 v4, v12, 2, s78
    ds_read_b32 v112, v4 offset:0
    ds_read_b32 v113, v4 offset:48
    ds_read_b32 v114, v4 offset:96
    v_lshl_add_u32 v13, v12, 16, v9
    v_mov_b32 v3, 0x40000000
    v_cmp_gt_u32 vcc, 4, v12
    s_lshl_b32 s69, s2, 8
    s_add_u32 s69, s69, s68
    v_cndmask_b32 v14, v13, v3, vcc
    s_add_u32 s72, s69, 786432
    s_add_u32 s75, s69, 1572864
    s_mov_b32 s76, 0xbf317218
K2_E1:
    ds_read_b32 v6, v5 offset:24
    s_waitcnt lgkmcnt(0)
    v_readfirstlane_b32 s66, v6
    s_nop 0
    s_cmp_ge_u32 s66, 8
    s_cbranch_scc1 K2_E2
    s_sleep 2
    s_branch K2_E1
K2_E2:
    ds_read_b128 v[16:19], v2 offset:0
    ds_read_b128 v[20:23], v2 offset:16384
    ds_read_b128 v[24:27], v2 offset:64
    ds_read_b128 v[28:31], v2 offset:16448
    ds_read_b128 v[32:35], v2 offset:4096
    ds_read_b128 v[36:39], v2 offset:20480
    ds_read_b128 v[40:43], v2 offset:4160
    ds_read_b128 v[44:47], v2 offset:20544
    ds_read_b128 v[48:51], v2 offset:8192
    ds_read_b128 v[52:55], v2 offset:24576
    ds_read_b128 v[56:59], v2 offset:8256
    ds_read_b128 v[60:63], v2 offset:24640
    ds_read_b128 v[64:67], v2 offset:12288
    ds_read_b128 v[68:71], v2 offset:28672
    s_waitcnt lgkmcnt(13)
    v_mfma_f32_16x16x32_bf16 v[120:123], v[144:147], v[16:19], 0
    ds_read_b128 v[72:75], v2 offset:12352
    s_waitcnt lgkmcnt(13)
    v_mfma_f32_16x16x32_bf16 v[124:127], v[144:147], v[20:23], 0
    ds_read_b128 v[76:79], v2 offset:28736
    s_waitcnt lgkmcnt(13)
    v_mfma_f32_16x16x32_bf16 v[120:123], v[148:151], v[24:27], v[120:123]
    s_waitcnt lgkmcnt(12)
    v_mfma_f32_16x16x32_bf16 v[124:127], v[148:151], v[28:31], v[124:127]
    s_waitcnt lgkmcnt(11)
    v_mfma_f32_16x16x32_bf16 v[120:123], v[152:155], v[32:35], v[120:123]
    s_waitcnt lgkmcnt(10)
    v_mfma_f32_16x16x32_bf16 v[124:127], v[152:155], v[36:39], v[124:127]
    s_waitcnt lgkmcnt(9)
    v_mfma_f32_16x16x32_bf16 v[120:123], v[156:159], v[40:43], v[120:123]
    s_waitcnt lgkmcnt(8)
    v_mfma_f32_16x16x32_bf16 v[124:127], v[156:159], v[44:47], v[124:127]
    s_waitcnt lgkmcnt(7)
    v_mfma_f32_16x16x32_bf16 v[120:123], v[160:163], v[48:51], v[120:123]
    s_waitcnt lgkmcnt(6)
    v_mfma_f32_16x16x32_bf16 v[124:127], v[160:163], v[52:55], v[124:127]
    s_waitcnt lgkmcnt(5)
    v_mfma_f32_16x16x32_bf16 v[120:123], v[96:99], v[56:59], v[120:123]
    s_waitcnt lgkmcnt(4)
    v_mfma_f32_16x16x32_bf16 v[124:127], v[96:99], v[60:63], v[124:127]
    s_waitcnt lgkmcnt(3)
    v_mfma_f32_16x16x32_bf16 v[120:123], v[100:103], v[64:67], v[120:123]
    s_waitcnt lgkmcnt(2)
    v_mfma_f32_16x16x32_bf16 v[124:127], v[100:103], v[68:71], v[124:127]
    s_waitcnt vmcnt(1) lgkmcnt(1)
    v_mfma_f32_16x16x32_bf16 v[120:123], v[116:119], v[72:75], v[120:123]
    s_waitcnt lgkmcnt(0)
    v_mfma_f32_16x16x32_bf16 v[124:127], v[116:119], v[76:79], v[124:127]
    s_waitcnt vmcnt(0)
    v_lshlrev_b32 v104, 16, v10
    v_and_b32 v105, 0xffff0000, v10
    v_lshlrev_b32 v106, 16, v11
    v_and_b32 v107, 0xffff0000, v11
    v_cvt_f32_u32 v112, v112
    v_cvt_f32_u32 v113, v113
    v_cvt_f32_u32 v114, v114
    v_mul_f32 v80, v112, v104
    v_mul_f32 v81, v112, v105
    v_mul_f32 v82, v112, v106
    v_mul_f32 v83, v112, v107
    v_mul_f32 v84, v113, v104
    v_mul_f32 v85, v113, v105
    v_mul_f32 v86, v113, v106
    v_mul_f32 v87, v113, v107
    v_mul_f32 v88, v114, v104
    v_mul_f32 v89, v114, v105
    v_mul_f32 v90, v114, v106
    v_mul_f32 v91, v114, v107
    v_add_f32_dpp v120, v124, v120 row_shr:12 row_mask:0xf bank_mask:0xf bound_ctrl:0
    v_add_f32_dpp v121, v125, v121 row_shr:12 row_mask:0xf bank_mask:0xf bound_ctrl:0
    v_add_f32_dpp v122, v126, v122 row_shr:12 row_mask:0xf bank_mask:0xf bound_ctrl:0
    v_add_f32_dpp v123, v127, v123 row_shr:12 row_mask:0xf bank_mask:0xf bound_ctrl:0
    v_fma_f32 v80, v120, s76, v80
    v_fma_f32 v81, v121, s76, v81
    v_fma_f32 v82, v122, s76, v82
    v_fma_f32 v83, v123, s76, v83
    v_cvt_pk_bf16_f32 v132, v80, v81
    v_cvt_pk_bf16_f32 v133, v82, v83
    buffer_store_dwordx2 v[132:133], v13, s[44:47], s69 offen sc1
    s_barrier
    ds_read_b128 v[16:19], v2 offset:32768
    ds_read_b128 v[20:23], v2 offset:32832
    ds_read_b128 v[24:27], v2 offset:36864
    ds_read_b128 v[28:31], v2 offset:36928
    ds_read_b128 v[32:35], v2 offset:40960
    ds_read_b128 v[36:39], v2 offset:41024
    ds_read_b128 v[40:43], v2 offset:45056
    ds_read_b128 v[44:47], v2 offset:45120
    ds_read_b32 v6, v5
    s_waitcnt lgkmcnt(8)
    v_mfma_f32_16x16x32_bf16 v[128:131], v[144:147], v[16:19], 0
    s_waitcnt lgkmcnt(7)
    v_mfma_f32_16x16x32_bf16 v[128:131], v[148:151], v[20:23], v[128:131]
    s_waitcnt lgkmcnt(6)
    v_mfma_f32_16x16x32_bf16 v[128:131], v[152:155], v[24:27], v[128:131]
    s_waitcnt lgkmcnt(5)
    v_mfma_f32_16x16x32_bf16 v[128:131], v[156:159], v[28:31], v[128:131]
    s_waitcnt lgkmcnt(4)
    v_mfma_f32_16x16x32_bf16 v[128:131], v[160:163], v[32:35], v[128:131]
    s_waitcnt lgkmcnt(3)
    v_mfma_f32_16x16x32_bf16 v[128:131], v[96:99], v[36:39], v[128:131]
    s_waitcnt lgkmcnt(2)
    v_mfma_f32_16x16x32_bf16 v[128:131], v[100:103], v[40:43], v[128:131]
    s_waitcnt lgkmcnt(1)
    v_mfma_f32_16x16x32_bf16 v[128:131], v[116:119], v[44:47], v[128:131]
    s_waitcnt lgkmcnt(0)
    v_readfirstlane_b32 s82, v6
    s_nop 1
    s_andn2_b32 s82, s82, s70
    s_cmp_lg_u32 s82, 0
    s_cbranch_scc1 K2_REDO
    s_nop 0
    v_add_f32_dpp v124, v128, v124 row_shr:12 row_mask:0xf bank_mask:0xf bound_ctrl:0
    v_add_f32_dpp v125, v129, v125 row_shr:12 row_mask:0xf bank_mask:0xf bound_ctrl:0
    v_add_f32_dpp v126, v130, v126 row_shr:12 row_mask:0xf bank_mask:0xf bound_ctrl:0
    v_add_f32_dpp v127, v131, v127 row_shr:12 row_mask:0xf bank_mask:0xf bound_ctrl:0
    v_fma_f32 v88, v128, s76, v88
    v_fma_f32 v89, v129, s76, v89
    v_fma_f32 v90, v130, s76, v90
    v_fma_f32 v91, v131, s76, v91
    v_cvt_pk_bf16_f32 v136, v88, v89
    v_cvt_pk_bf16_f32 v137, v90, v91
    buffer_store_dwordx2 v[136:137], v14, s[44:47], s75 offen sc1
    v_fma_f32 v84, v124, s76, v84
    v_fma_f32 v85, v125, s76, v85
    v_fma_f32 v86, v126, s76, v86
    v_fma_f32 v87, v127, s76, v87
    v_cvt_pk_bf16_f32 v134, v84, v85
    v_cvt_pk_bf16_f32 v135, v86, v87
    buffer_store_dwordx2 v[134:135], v14, s[44:47], s72 offen sc1
K2_END2:
K2_END:
    s_endpgm
K2_HEND:
    s_waitcnt lgkmcnt(0)
    s_barrier
    ds_read_b32 v6, v5
    s_waitcnt lgkmcnt(0)
    v_readfirstlane_b32 s82, v6
    s_nop 0
    s_andn2_b32 s82, s82, s70
    s_cmp_lg_u32 s82, 0
    s_cbranch_scc1 K2_REDO
    s_branch K2_END2
K2_CX:
    s_mov_b32 s81, 2
    v_and_b32 v37, 63, v21
    v_lshrrev_b32 v93, 29, v21
    v_lshl_add_u32 v37, v37, 2, s78
    v_lshl_add_u32 v37, v93, 8, v37
    v_and_b32 v38, 63, v22
    v_lshrrev_b32 v94, 29, v22
    v_lshl_add_u32 v38, v38, 2, s78
    v_lshl_add_u32 v38, v94, 8, v38
    v_and_b32 v39, 63, v23
    v_lshrrev_b32 v95, 29, v23
    v_lshl_add_u32 v39, v39, 2, s78
    v_lshl_add_u32 v39, v95, 8, v39
    v_cmpx_gt_u32 vcc, -2, v21
    ds_add_rtn_u32 v45, v37, v114
    v_cmpx_gt_u32 vcc, -2, v22
    ds_add_rtn_u32 v46, v38, v114
    v_cmpx_gt_u32 vcc, -2, v23
    ds_add_rtn_u32 v47, v39, v114
    s_mov_b64 exec, -1
    v_lshrrev_b32 v121, 18, v21
    v_bfe_u32 v129, v21, 6, 12
    v_add_u32 v129, v129, v72
    v_and_b32 v61, 15, v21
    v_lshl_add_u32 v61, v61, 1, s80
    v_mad_i32_i24 v93, v93, -7, 28
    v_lshrrev_b32 v122, 18, v22
    v_bfe_u32 v130, v22, 6, 12
    v_add_u32 v130, v130, v72
    v_and_b32 v62, 15, v22
    v_lshl_add_u32 v62, v62, 1, s80
    v_mad_i32_i24 v94, v94, -7, 28
    v_lshrrev_b32 v123, 18, v23
    v_bfe_u32 v131, v23, 6, 12
    v_add_u32 v131, v131, v72
    v_and_b32 v63, 15, v23
    v_lshl_add_u32 v63, v63, 1, s80
    v_mad_i32_i24 v95, v95, -7, 28
    v_cmpx_eq_u32 vcc, -2, v23
    ds_write_b32 v111, v114
    s_mov_b64 exec, -1
    s_branch K2_C1
K2_SY:
    ds_bpermute_b32 v101, v37, v31
    ds_bpermute_b32 v102, v38, v31
    ds_bpermute_b32 v103, v39, v31
    s_waitcnt lgkmcnt(0)
    v_bfe_u32 v101, v101, v93, 7
    v_add_u32_sdwa v101, v101, v45 dst_sel:DWORD dst_unused:UNUSED_PAD src0_sel:DWORD src1_sel:WORD_0
    v_add_u32_sdwa v93, v101, v45 dst_sel:DWORD dst_unused:UNUSED_PAD src0_sel:DWORD src1_sel:WORD_1
    v_lshrrev_b32 v69, 2, v101
    v_mad_u32_u24 v93, v69, v74, v93
    v_lshl_add_u32 v69, v93, 5, v61
    v_lshl_add_u32 v93, v93, 2, s79
    v_cmpx_gt_u32 vcc, 24, v101
    ds_write2st64_b32 v93, v121, v129 offset0:0 offset1:25
    ds_write_b16 v69, v75
    s_mov_b64 exec, -1
    v_bfe_u32 v102, v102, v94, 7
    v_add_u32_sdwa v102, v102, v46 dst_sel:DWORD dst_unused:UNUSED_PAD src0_sel:DWORD src1_sel:WORD_0
    v_add_u32_sdwa v94, v102, v46 dst_sel:DWORD dst_unused:UNUSED_PAD src0_sel:DWORD src1_sel:WORD_1
    v_lshrrev_b32 v70, 2, v102
    v_mad_u32_u24 v94, v70, v74, v94
    v_lshl_add_u32 v70, v94, 5, v62
    v_lshl_add_u32 v94, v94, 2, s79
    v_cmpx_gt_u32 vcc, 24, v102
    ds_write2st64_b32 v94, v122, v130 offset0:0 offset1:25
    ds_write_b16 v70, v75
    s_mov_b64 exec, -1
    v_bfe_u32 v103, v103, v95, 7
    v_add_u32_sdwa v103, v103, v47 dst_sel:DWORD dst_unused:UNUSED_PAD src0_sel:DWORD src1_sel:WORD_0
    v_add_u32_sdwa v95, v103, v47 dst_sel:DWORD dst_unused:UNUSED_PAD src0_sel:DWORD src1_sel:WORD_1
    v_lshrrev_b32 v71, 2, v103
    v_mad_u32_u24 v95, v71, v74, v95
    v_lshl_add_u32 v71, v95, 5, v63
    v_lshl_add_u32 v95, v95, 2, s79
    v_cmpx_gt_u32 vcc, 24, v103
    ds_write2st64_b32 v95, v123, v131 offset0:0 offset1:25
    ds_write_b16 v71, v75
    s_mov_b64 exec, -1
    s_branch K2_S0
K2_SX:
    ds_bpermute_b32 v53, v37, v108
    ds_bpermute_b32 v54, v38, v108
    ds_bpermute_b32 v55, v39, v108
    s_waitcnt lgkmcnt(0)
    v_add_u32 v53, v53, v101
    v_cmp_gt_u32 vcc, s76, v53
    v_cmp_gt_u32 s[68:69], s77, v53
    v_cmpx_le_u32 s[82:83], 24, v101
    v_cmpx_gt_u32 s[82:83], -2, v21
    v_cndmask_b32 v69, v107, v106, s[68:69]
    v_cndmask_b32 v69, v69, v105, vcc
    v_add_u32 v53, v53, v69
    v_lshl_add_u32 v61, v53, 5, v61
    v_lshl_add_u32 v53, v53, 2, s79
    ds_write2st64_b32 v53, v121, v129 offset0:0 offset1:25
    ds_write_b16 v61, v75
    s_mov_b64 exec, -1
    v_add_u32 v54, v54, v102
    v_cmp_gt_u32 vcc, s76, v54
    v_cmp_gt_u32 s[68:69], s77, v54
    v_cmpx_le_u32 s[82:83], 24, v102
    v_cmpx_gt_u32 s[82:83], -2, v22
    v_cndmask_b32 v70, v107, v106, s[68:69]
    v_cndmask_b32 v70, v70, v105, vcc
    v_add_u32 v54, v54, v70
    v_lshl_add_u32 v62, v54, 5, v62
    v_lshl_add_u32 v54, v54, 2, s79
    ds_write2st64_b32 v54, v122, v130 offset0:0 offset1:25
    ds_write_b16 v62, v75
    s_mov_b64 exec, -1
    v_add_u32 v55, v55, v103
    v_cmp_gt_u32 vcc, s76, v55
    v_cmp_gt_u32 s[68:69], s77, v55
    v_cmpx_le_u32 s[82:83], 24, v103
    v_cmpx_gt_u32 s[82:83], -2, v23
    v_cndmask_b32 v71, v107, v106, s[68:69]
    v_cndmask_b32 v71, v71, v105, vcc
    v_add_u32 v55, v55, v71
    v_lshl_add_u32 v63, v55, 5, v63
    v_lshl_add_u32 v55, v55, 2, s79
    ds_write2st64_b32 v55, v123, v131 offset0:0 offset1:25
    ds_write_b16 v63, v75
    s_mov_b64 exec, -1
    s_branch K2_S1
K2_REDO:
    s_setprio 0
    s_mov_b32 s70, -1
    s_lshl_b32 s66, s24, 6
    v_add_u32 v0, s66, v1
    s_waitcnt vmcnt(0) lgkmcnt(0)
    s_barrier
    s_branch K2_TOP
K2_BAD:
    s_mov_b64 exec, 1
    ds_add_u32 v111, v114 offset:8
    s_mov_b64 exec, -1
    v_mov_b32 v109, -1
    ds_write_b32 v111, v109 offset:16
    s_mov_b64 exec, 1
    ds_add_u32 v111, v114 offset:40
    s_mov_b64 exec, -1
K2_SLOW:
    v_lshrrev_b32 v1, 4, v6
    s_setprio 0
    s_mov_b32 s70, -1
    s_waitcnt vmcnt(0) lgkmcnt(0)
    s_barrier
    s_lshl_b32 s66, s24, 10
    s_add_u32 s66, s66, 98304
    v_lshl_add_u32 v2, v1, 4, s66
    v_mov_b32 v4, 0
    v_mov_b32 v5, 0
    v_mov_b32 v6, 0
    v_mov_b32 v7, 0
    ds_write_b128 v2, v[4:7] offset:0
    ds_write_b128 v2, v[4:7] offset:12288
    ds_write_b128 v2, v[4:7] offset:24576
    ds_write_b128 v2, v[4:7] offset:36864
    v_lshlrev_b32 v12, 2, v1
    v_add_u32 v3, 148992, v12
    ds_write_b32 v3, v4
    s_mov_b32 s84, s8
    s_mov_b32 s85, s9
    s_mov_b32 s86, 1280000
    s_mov_b32 s87, 0x00020000
    s_mov_b32 s88, s10
    s_mov_b32 s89, s11
    s_mov_b32 s90, 1280000
    s_mov_b32 s91, 0x00020000
    v_and_b32 v8, 31, v1
    v_lshlrev_b32 v8, 4, v8
    v_lshrrev_b32 v9, 5, v1
    v_lshl_add_u32 v8, v9, 10, v8
    s_lshl_b32 s72, s25, 11
    s_add_u32 s66, s72, 4325376
    buffer_load_dwordx4 v[16:19], v8, s[40:43], s66 offen
    buffer_load_dwordx4 v[20:23], v8, s[40:43], s66 offen offset:512
    s_add_u32 s72, s72, 57344
    v_add_u32 v8, s72, v8
    v_lshlrev_b32 v7, 4, v1
    buffer_load_dwordx4 v[144:147], v7, s[40:43], s73 offen offset:0
    buffer_load_dwordx4 v[148:151], v7, s[40:43], s73 offen offset:1024
    buffer_load_dwordx4 v[152:155], v7, s[40:43], s73 offen offset:2048
    buffer_load_dwordx4 v[156:159], v7, s[40:43], s73 offen offset:3072
    buffer_load_dwordx4 v[160:163], v7, s[40:43], s74 offen offset:0
    buffer_load_dwordx4 v[96:99], v7, s[40:43], s74 offen offset:1024
    buffer_load_dwordx4 v[100:103], v7, s[40:43], s74 offen offset:2048
    s_add_u32 s92, s22, 4096
    s_addc_u32 s93, s23, 0
    s_mov_b32 s94, 5120000
    s_mov_b32 s95, 0x00020000
    v_lshlrev_b32 v10, 1, v1
    v_add_u32 v10, s58, v10
    v_lshlrev_b32 v11, 1, v10
    v_add_u32 v11, 98304, v11
    v_mov_b32 v13, 1
    s_waitcnt vmcnt(0)
    v_lshlrev_b32 v24, 16, v16
    v_and_b32 v25, 0xffff0000, v16
    v_lshlrev_b32 v26, 16, v17
    v_and_b32 v27, 0xffff0000, v17
    v_lshlrev_b32 v28, 16, v18
    v_and_b32 v29, 0xffff0000, v18
    v_lshlrev_b32 v30, 16, v19
    v_and_b32 v31, 0xffff0000, v19
    v_lshlrev_b32 v32, 16, v20
    v_and_b32 v33, 0xffff0000, v20
    v_lshlrev_b32 v34, 16, v21
    v_and_b32 v35, 0xffff0000, v21
    v_lshlrev_b32 v36, 16, v22
    v_and_b32 v37, 0xffff0000, v22
    v_lshlrev_b32 v38, 16, v23
    v_and_b32 v39, 0xffff0000, v23
    s_waitcnt lgkmcnt(0)
    s_barrier
    s_mov_b32 s66, s26
K2_SL_BLK:
    s_lshl_b32 s67, s66, 8
    buffer_load_dword v40, v12, s[88:91], s67 offen
    buffer_load_dword v41, v12, s[84:87], s67 offen
    s_waitcnt vmcnt(0)
    v_and_b32 v42, 255, v40
    v_cmp_eq_u32 vcc, s2, v42
    s_nop 1
    s_mov_b64 s[68:69], vcc
K2_SL_E:
    s_cmp_eq_u64 s[68:69], 0
    s_cbranch_scc1 K2_SL_NB
    s_ff1_i32_b64 s72, s[68:69]
    s_bitset0_b64 s[68:69], s72
    v_readlane_b32 s52, v40, s72
    v_readlane_b32 s53, v41, s72
    s_lshl_b32 s75, s66, 6
    s_add_u32 s75, s75, s72
    s_lshl_b32 s75, s75, 5
    s_load_dwordx8 s[76:83], s[6:7], s75
    s_lshl_b32 s53, s53, 9
    s_lshr_b32 s52, s52, 8
    s_cmp_ge_u32 s52, 16
    s_cselect_b32 s75, 16384, 0
    s_cmp_ge_u32 s52, 28
    s_cselect_b32 s75, 32768, s75
    s_bfe_u32 s55, s52, 0x10003
    s_lshl_b32 s55, s55, 9
    s_add_u32 s75, s75, s55
    s_and_b32 s55, s52, 7
    s_lshl_b32 s55, s55, 1
    s_add_u32 s75, s75, s55
    v_add_u32 v45, s75, v8
    buffer_load_ushort v43, v10, s[92:95], s53 offen
    ds_read_u16 v44, v45
    s_waitcnt vmcnt(0) lgkmcnt(0)
    v_lshlrev_b32 v43, 16, v43
    v_lshlrev_b32 v44, 16, v44
    v_add_f32 v43, v43, v44
    s_lshl_b32 s53, s76, 16
    v_fmac_f32 v43, s53, v24
    s_and_b32 s53, s76, 0xffff0000
    v_fmac_f32 v43, s53, v25
    s_lshl_b32 s53, s77, 16
    v_fmac_f32 v43, s53, v26
    s_and_b32 s53, s77, 0xffff0000
    v_fmac_f32 v43, s53, v27
    s_lshl_b32 s53, s78, 16
    v_fmac_f32 v43, s53, v28
    s_and_b32 s53, s78, 0xffff0000
    v_fmac_f32 v43, s53, v29
    s_lshl_b32 s53, s79, 16
    v_fmac_f32 v43, s53, v30
    s_and_b32 s53, s79, 0xffff0000
    v_fmac_f32 v43, s53, v31
    s_lshl_b32 s53, s80, 16
    v_fmac_f32 v43, s53, v32
    s_and_b32 s53, s80, 0xffff0000
    v_fmac_f32 v43, s53, v33
    s_lshl_b32 s53, s81, 16
    v_fmac_f32 v43, s53, v34
    s_and_b32 s53, s81, 0xffff0000
    v_fmac_f32 v43, s53, v35
    s_lshl_b32 s53, s82, 16
    v_fmac_f32 v43, s53, v36
    s_and_b32 s53, s82, 0xffff0000
    v_fmac_f32 v43, s53, v37
    s_lshl_b32 s53, s83, 16
    v_fmac_f32 v43, s53, v38
    s_and_b32 s53, s83, 0xffff0000
    v_fmac_f32 v43, s53, v39
    v_exp_f32 v44, v43
    s_lshl_b32 s53, s52, 10
    v_add_f32 v44, 1.0, v44
    v_rcp_f32 v44, v44
    v_add_u32 v45, s53, v11
    v_mul_f32 v43, v43, v44
    ds_add_f32 v45, v43
    s_cmp_lg_u32 s25, 0
    s_cbranch_scc1 K2_SL_E
    s_lshl_b32 s53, s52, 2
    s_add_u32 s53, s53, 148992
    v_mov_b32 v45, s53
    s_mov_b64 exec, 1
    ds_add_u32 v45, v13
    s_mov_b64 exec, -1
    s_branch K2_SL_E
K2_SL_NB:
    s_add_u32 s66, s66, 3
    s_cmp_lt_u32 s66, 5000
    s_cbranch_scc1 K2_SL_BLK
    s_waitcnt lgkmcnt(0)
    s_barrier
    v_and_b32 v2, 31, v1
    v_lshrrev_b32 v3, 5, v1
    s_mov_b32 s66, 0
K2_SL_CV:
    v_add_u32 v4, s66, v3
    v_add_u32 v5, s71, v4
    s_cmp_lt_u32 s66, 4
    s_cselect_b32 s67, s26, 0
    s_cmp_lg_u32 s67, 0
    s_cbranch_scc0 K2_SL_NZ
    v_mov_b32 v5, 47
K2_SL_NZ:
    v_lshlrev_b32 v5, 10, v5
    v_lshl_add_u32 v5, v2, 3, v5
    s_lshl_b32 s67, s58, 1
    s_add_u32 s67, s67, 98304
    v_add_u32 v5, s67, v5
    ds_read_b64 v[6:7], v5
    v_mul_u32_u24 v4, 160, v4
    v_lshl_add_u32 v4, v2, 2, v4
    v_add_u32 v4, s57, v4
    s_waitcnt lgkmcnt(0)
    v_cvt_pk_bf16_f32 v6, v6, v7
    ds_write_b32 v4, v6
    s_add_u32 s66, s66, 2
    s_cmp_lt_u32 s66, 16
    s_cbranch_scc1 K2_SL_CV
    v_lshlrev_b32 v7, 4, v1
    s_mov_b32 s48, s18
    s_mov_b32 s49, s19
    s_mov_b32 s50, 256
    s_mov_b32 s51, 0x00020000
    buffer_load_dwordx4 v[116:119], v7, s[40:43], s74 offen offset:3072
    v_lshrrev_b32 v8, 4, v1
    v_lshlrev_b32 v9, 3, v8
    s_lshl_b32 s68, s24, 5
    buffer_load_dwordx2 v[10:11], v9, s[48:51], s68 offen
    v_mov_b32 v5, 148736
    v_mov_b32 v7, 1
    s_branch K2_FIN
.section .rodata,"a"
.p2align 6
.amdhsa_kernel mpnn_pre_kernel
  .amdhsa_next_free_vgpr 112
  .amdhsa_next_free_sgpr 64
  .amdhsa_accum_offset 112
  .amdhsa_group_segment_fixed_size 0
  .amdhsa_kernarg_size 88
  .amdhsa_user_sgpr_count 2
  .amdhsa_user_sgpr_kernarg_segment_ptr 1
  .amdhsa_system_sgpr_workgroup_id_x 1
  .amdhsa_float_denorm_mode_32 3
.end_amdhsa_kernel
.p2align 6
.amdhsa_kernel mpnn_main_kernel
  .amdhsa_next_free_vgpr 168
  .amdhsa_next_free_sgpr 96
  .amdhsa_accum_offset 168
  .amdhsa_group_segment_fixed_size 0
  .amdhsa_kernarg_size 88
  .amdhsa_user_sgpr_count 2
  .amdhsa_user_sgpr_kernarg_segment_ptr 1
  .amdhsa_system_sgpr_workgroup_id_x 1
  .amdhsa_float_denorm_mode_32 3
.end_amdhsa_kernel
```
